```python
import torch

def _softmax(x, axis=-1):
    return torch.softmax(x, dim=axis)
def _gelu(x):
    return torch.nn.functional.gelu(x, approximate="tanh")
def _silu(x):
    return torch.nn.functional.silu(x)
def _sigmoid(x):
    return torch.sigmoid(x)
def _layernorm(x, axis=-1, eps=1e-5):
    m = x.mean(dim=axis, keepdim=True)
    v = x.var(dim=axis, keepdim=True, unbiased=False)
    return (x - m) / torch.sqrt(v + eps)
def _scatter_add(tgt, idx, src, axis=0):
    return tgt.clone().index_add_(axis, idx, src)
def _segment_sum(src, seg, n):
    out = torch.zeros((n,) + src.shape[1:], dtype=src.dtype)
    return out.index_add_(0, seg, src)
def _pad(x, pw):
    flat = tuple(v for pair in reversed(pw) for v in pair)
    return torch.nn.functional.pad(x, flat)

kernel_name = 'recurrent_scan__ssm_conv_s4__mixer_channel_mlp__prompt'

def setup_inputs():

    _w = (lambda a: (lambda t: t.to(torch.bfloat16) if t.is_floating_point() else t)(torch.as_tensor(a)))
    def _A_setup():
        B, L, D, N = 1, 2048, 640, 128
        A_re = -(lambda _x: torch.exp(torch.as_tensor(_x)))((lambda *s: torch.randn(*s, dtype=torch.bfloat16) * 3.2)(D, N))
        A_im = torch.pi * (lambda *s: torch.randn(*s, dtype=torch.bfloat16) * 0.05)(D, N)
        B_re = (lambda *s: torch.randn(*s, dtype=torch.bfloat16) * 0.2)(D, N)
        B_im = (lambda *s: torch.randn(*s, dtype=torch.bfloat16) * 0.2)(D, N)
        C_re = (lambda *s: torch.randn(*s, dtype=torch.bfloat16) * 0.2)(D, N)
        C_im = (lambda *s: torch.randn(*s, dtype=torch.bfloat16) * 0.2)(D, N)
        log_dt = (lambda *s: torch.randn(*s, dtype=torch.bfloat16) * 0.05)(D) * 0.5 - 4.0
        Dskip = (lambda *s: torch.randn(*s, dtype=torch.bfloat16) * 0.05)(D)
        return {
            "u": _w((lambda *s: torch.randn(*s, dtype=torch.bfloat16) * 0.05)(B, L, D)),
            "A_re": _w(A_re),
            "A_im": _w(A_im),
            "B_re": _w(B_re),
            "B_im": _w(B_im),
            "C_re": _w(C_re),
            "C_im": _w(C_im),
            "log_dt": _w(log_dt),
            "Dskip": _w(Dskip),
        }
    _A_in = _A_setup()

    def _B_setup():
        B, S, D, F = 1, 2048, 640, 1728
        return {
            "x": _w((lambda *s: torch.randn(*s, dtype=torch.bfloat16) * 0.05)(B, S, D)),
            "w1": _w((lambda *s: torch.randn(*s, dtype=torch.bfloat16) * 3.2)(D, F) * (D ** -0.5)),
            "b1": _w((lambda *s: torch.randn(*s, dtype=torch.bfloat16) * 0.8)(F)),
            "w2": _w((lambda *s: torch.randn(*s, dtype=torch.bfloat16) * 0.05)(F, D) * (F ** -0.5)),
            "b2": _w((lambda *s: torch.randn(*s, dtype=torch.bfloat16) * 0.05)(D)),
        }
    _B_in = _B_setup()

    return {
        "A_u": _A_in["u"],
        "A_A_re": _A_in["A_re"],
        "A_A_im": _A_in["A_im"],
        "A_B_re": _A_in["B_re"],
        "A_B_im": _A_in["B_im"],
        "A_C_re": _A_in["C_re"],
        "A_C_im": _A_in["C_im"],
        "A_log_dt": _A_in["log_dt"],
        "A_Dskip": _A_in["Dskip"],
        "B_x": _B_in["x"],
        "B_w1": _B_in["w1"],
        "B_b1": _B_in["b1"],
        "B_w2": _B_in["w2"],
        "B_b2": _B_in["b2"],
    }

def reference(A_u, A_A_re, A_A_im, A_B_re, A_B_im, A_C_re, A_C_im, A_log_dt, A_Dskip, B_x, B_w1, B_b1, B_w2, B_b2):
    def _A_ref(u, A_re, A_im, B_re, B_im, C_re, C_im, log_dt, Dskip):
        Bsz, L, D = u.shape
        dt = torch.exp(log_dt)[:, None]
        A = A_re + 1j * A_im
        Bc = B_re + 1j * B_im
        Cc = C_re + 1j * C_im
        logdA = dt * A
        dB = dt * Bc
        l = (lambda x, dt: x.to(dt))(torch.arange(L), A_re.dtype)
        P = torch.exp(logdA[:, :, None] * l[None, None, :])
        K = torch.einsum("dn,dnl,dn->dl", Cc, P, dB).real
        L2 = 2 * L
        Kp = _pad(K, ((0, 0), (0, L)))
        up = (lambda x, *d: x.permute(*d))(u, 0, 2, 1)
        up = _pad(up, ((0, 0), (0, 0), (0, L)))
        Kf = (lambda x, axes=(-2,-1): torch.fft.rfft2(x.float(), dim=axes))(Kp[:, None, :], axes=(-2, -1))
        Uf = (lambda x, axes=(-2,-1): torch.fft.rfft2(x.float(), dim=axes))(up[:, :, None, :], axes=(-2, -1))
        Yf = Uf * Kf[None, :, :, :]
        y = (lambda x, s, axes=(-2,-1): torch.fft.irfft2(x, s=s, dim=axes).to(torch.bfloat16))(Yf, (1, L2), axes=(-2, -1))[:, :, 0, :L]
        y = (lambda x, *d: x.permute(*d))(y, 0, 2, 1) + u * Dskip[None, None, :]
        return y

    def _B_ref(x, w1, b1, w2, b2):
        y = _layernorm(x, axis=-1)
        h = _gelu(torch.einsum("bsd,df->bsf", y, w1) + b1)
        return torch.einsum("bsf,fd->bsd", h, w2) + b2

    x = A_u
    xn = _layernorm(x, axis=-1)
    s = _A_ref(xn, A_A_re, A_A_im, A_B_re, A_B_im, A_C_re, A_C_im, A_log_dt, A_Dskip)
    g = _silu(_B_ref(xn, B_w1, B_b1, B_w2, B_b2))
    return x + s * g
```

```asm
; @launch kernel=k1_kernel grid=(288,1,1) block=(256,1,1) lds=81920
; @launch kernel=k2_kernel grid=(416,1,1) block=(256,1,1) lds=73728
.amdgcn_target "amdgcn-amd-amdhsa--gfx950"
.text
.globl k1_kernel
.p2align 8
.type k1_kernel,@function
k1_kernel:
  s_cmp_lt_u32 s2, 32
  s_cbranch_scc1 L_role
  s_cmp_lt_u32 s2, 256
  s_cbranch_scc1 G1_role
  s_cmp_lt_u32 s2, 288
  s_cbranch_scc1 L_role
k1_exit:
  s_endpgm
G1_role:
  s_load_dwordx2 s[8:9], s[0:1], 0
  s_load_dwordx2 s[16:17], s[0:1], 80
  s_load_dwordx2 s[12:13], s[0:1], 128
  s_load_dwordx2 s[20:21], s[0:1], 88
  s_load_dwordx2 s[24:25], s[0:1], 96
  s_mov_b32 s10, 2621440
  s_mov_b32 s11, 0x20000
  s_mov_b32 s14, 19922944
  s_mov_b32 s15, 0x20000
  s_mov_b32 s18, 2211840
  s_mov_b32 s19, 0x20000
  s_mov_b32 s22, 3456
  s_mov_b32 s23, 0x20000
  s_mov_b32 s26, 2211840
  s_mov_b32 s27, 0x20000
  s_sub_u32 s28, s2, 32
  s_and_b32 s29, s28, 7
  s_lshr_b32 s30, s28, 3
  s_and_b32 s31, s30, 3
  s_lshr_b32 s32, s30, 2
  s_lshr_b32 s33, s29, 1
  s_lshl_b32 s33, s33, 2
  s_add_u32 s33, s33, s31
  s_and_b32 s34, s29, 1
  s_mul_i32 s34, s34, 7
  s_add_u32 s34, s34, s32
  s_mul_i32 s35, s31, 40
  s_mul_i32 s36, s32, 23
  s_add_u32 s35, s35, s36
  s_lshr_b32 s35, s35, 4
  s_cmp_ge_u32 s35, 10
  s_cselect_b32 s36, 10, 0
  s_sub_u32 s35, s35, s36
  v_lshrrev_b32 v4, 6, v0
  v_and_b32 v1, 63, v0
  s_mul_i32 s38, s33, 163840
  v_readfirstlane_b32 s37, v4
  s_lshl_b32 s39, s34, 8
  v_lshrrev_b32 v2, 3, v1
  v_and_b32 v3, 7, v1
  s_lshl_b32 s40, s37, 5
  v_add_u32 v5, 0, v2
  v_add_u32 v5, s40, v5
  v_bfe_u32 v6, v5, 1, 3
  v_xor_b32 v6, v6, v3
  v_mul_u32_u24 v5, 1280, v5
  v_lshl_add_u32 v5, v6, 4, v5
  v_add_u32 v5, s38, v5
  v_subrev_u32 v8, 0, v5
  v_add_u32 v5, 8, v2
  v_add_u32 v5, s40, v5
  v_bfe_u32 v6, v5, 1, 3
  v_xor_b32 v6, v6, v3
  v_mul_u32_u24 v5, 1280, v5
  v_lshl_add_u32 v5, v6, 4, v5
  v_add_u32 v5, s38, v5
  v_subrev_u32 v9, 1024, v5
  v_add_u32 v5, 16, v2
  v_add_u32 v5, s40, v5
  v_bfe_u32 v6, v5, 1, 3
  v_xor_b32 v6, v6, v3
  v_mul_u32_u24 v5, 1280, v5
  v_lshl_add_u32 v5, v6, 4, v5
  v_add_u32 v5, s38, v5
  v_subrev_u32 v10, 2048, v5
  v_add_u32 v5, 24, v2
  v_add_u32 v5, s40, v5
  v_bfe_u32 v6, v5, 1, 3
  v_xor_b32 v6, v6, v3
  v_mul_u32_u24 v5, 1280, v5
  v_lshl_add_u32 v5, v6, 4, v5
  v_add_u32 v5, s38, v5
  v_subrev_u32 v11, 3072, v5
  v_lshrrev_b32 v2, 4, v1
  v_and_b32 v3, 15, v1
  v_lshlrev_b32 v6, 2, v2
  v_xor_b32 v6, v6, v3
  s_cmp_eq_u32 s34, 13
  s_cselect_b32 s40, 7, 15
  v_and_b32 v6, s40, v6
  s_lshl_b32 s40, s37, 3
  v_add_u32 v5, 0, v2
  v_add_u32 v5, s40, v5
  v_mul_u32_u24 v5, 3456, v5
  v_lshl_add_u32 v5, v6, 4, v5
  v_add_u32 v5, s39, v5
  v_subrev_u32 v12, 0, v5
  v_add_u32 v5, 4, v2
  v_add_u32 v5, s40, v5
  v_mul_u32_u24 v5, 3456, v5
  v_lshl_add_u32 v5, v6, 4, v5
  v_add_u32 v5, s39, v5
  v_subrev_u32 v13, 1024, v5
  s_lshl_b32 s41, s37, 12
  s_add_u32 s41, s41, 32768
  s_lshl_b32 s42, s37, 11
  s_mov_b32 s43, s35
  s_mov_b32 s44, s35
  s_waitcnt lgkmcnt(0)
  s_lshl_b32 s45, s43, 7
  s_add_u32 s43, s43, 1
  s_cmp_eq_u32 s43, 10
  s_cselect_b32 s43, 0, s43
  s_add_u32 m0, s41, 0
  s_nop 0
  buffer_load_dwordx4 v8, s[8:11], s45 offen offset:0 lds
  buffer_load_dwordx4 v9, s[8:11], s45 offen offset:1024 lds
  buffer_load_dwordx4 v10, s[8:11], s45 offen offset:2048 lds
  buffer_load_dwordx4 v11, s[8:11], s45 offen offset:3072 lds
  s_mul_i32 s46, s44, 221184
  s_add_u32 m0, s42, 0
  s_nop 0
  buffer_load_dwordx4 v12, s[16:19], s46 offen lds
  buffer_load_dwordx4 v13, s[16:19], s46 offen offset:1024 lds
  s_mul_i32 s46, s44, 221184
  s_add_u32 s46, s46, 110592
  s_add_u32 s44, s44, 1
  s_cmp_eq_u32 s44, 10
  s_cselect_b32 s44, 0, s44
  s_add_u32 m0, s42, 8192
  s_nop 0
  buffer_load_dwordx4 v12, s[16:19], s46 offen lds
  buffer_load_dwordx4 v13, s[16:19], s46 offen offset:1024 lds
  s_lshl_b32 s45, s43, 7
  s_add_u32 s43, s43, 1
  s_cmp_eq_u32 s43, 10
  s_cselect_b32 s43, 0, s43
  s_add_u32 m0, s41, 16384
  s_nop 0
  buffer_load_dwordx4 v8, s[8:11], s45 offen offset:0 lds
  buffer_load_dwordx4 v9, s[8:11], s45 offen offset:1024 lds
  buffer_load_dwordx4 v10, s[8:11], s45 offen offset:2048 lds
  buffer_load_dwordx4 v11, s[8:11], s45 offen offset:3072 lds
  s_mul_i32 s46, s44, 221184
  s_add_u32 m0, s42, 16384
  s_nop 0
  buffer_load_dwordx4 v12, s[16:19], s46 offen lds
  buffer_load_dwordx4 v13, s[16:19], s46 offen offset:1024 lds
  s_mul_i32 s46, s44, 221184
  s_add_u32 s46, s46, 110592
  s_add_u32 s44, s44, 1
  s_cmp_eq_u32 s44, 10
  s_cselect_b32 s44, 0, s44
  s_add_u32 m0, s42, 24576
  s_nop 0
  buffer_load_dwordx4 v12, s[16:19], s46 offen lds
  buffer_load_dwordx4 v13, s[16:19], s46 offen offset:1024 lds
  s_lshl_b32 s45, s43, 7
  s_add_u32 s43, s43, 1
  s_cmp_eq_u32 s43, 10
  s_cselect_b32 s43, 0, s43
  s_add_u32 m0, s41, 32768
  s_nop 0
  buffer_load_dwordx4 v8, s[8:11], s45 offen offset:0 lds
  buffer_load_dwordx4 v9, s[8:11], s45 offen offset:1024 lds
  buffer_load_dwordx4 v10, s[8:11], s45 offen offset:2048 lds
  buffer_load_dwordx4 v11, s[8:11], s45 offen offset:3072 lds
  s_setprio 2
  s_and_b32 s47, s37, 1
  s_lshr_b32 s48, s37, 1
  v_and_b32 v2, 31, v1
  v_lshrrev_b32 v3, 5, v1
  v_bfe_u32 v5, v2, 1, 3
  v_xor_b32 v5, v5, v3
  s_lshl_b32 s49, s47, 13
  s_lshl_b32 s50, s48, 12
  s_add_u32 s49, s49, s50
  s_add_u32 s49, s49, 32768
  v_lshlrev_b32 v6, 7, v2
  v_add_u32 v6, s49, v6
  v_xor_b32 v7, 0, v5
  v_lshl_add_u32 v16, v7, 4, v6
  v_xor_b32 v20, 0x1000, v16
  v_xor_b32 v7, 2, v5
  v_lshl_add_u32 v17, v7, 4, v6
  v_xor_b32 v21, 0x1000, v17
  v_xor_b32 v7, 4, v5
  v_lshl_add_u32 v18, v7, 4, v6
  v_xor_b32 v22, 0x1000, v18
  v_xor_b32 v7, 6, v5
  v_lshl_add_u32 v19, v7, 4, v6
  v_xor_b32 v23, 0x1000, v19
  v_bfe_u32 v5, v1, 2, 2
  v_lshl_add_u32 v6, v3, 3, v5
  v_lshlrev_b32 v6, 8, v6
  v_bfe_u32 v7, v1, 4, 1
  v_lshl_add_u32 v6, v7, 5, v6
  v_and_b32 v7, 3, v1
  v_lshl_add_u32 v6, v7, 3, v6
  s_lshl_b32 s49, s48, 1
  s_add_u32 s49, s49, s47
  v_xor_b32 v5, s49, v5
  v_lshl_add_u32 v24, v5, 6, v6
  v_xor_b32 v5, 1, v5
  v_lshl_add_u32 v25, v5, 6, v6
  v_lshrrev_b32 v5, 4, v1
  v_xor_b32 v5, v5, v1
  v_and_b32 v5, 1, v5
  v_cmp_eq_u32 vcc, 0, v5
  v_mov_b32 v6, 0x3f803f80
  s_nop 0
  v_cndmask_b32 v160, 0, v6, vcc
  v_cndmask_b32 v161, 0, v6, vcc
  v_cndmask_b32 v162, 0, v6, vcc
  v_cndmask_b32 v163, 0, v6, vcc
  v_mov_b32 v172, 0
  v_mov_b32 v173, 0
  v_lshlrev_b32 v5, 1, v2
  s_lshl_b32 s50, s48, 7
  s_lshl_b32 s51, s47, 6
  s_add_u32 s50, s50, s51
  s_add_u32 s50, s50, s39
  s_xor_b32 s51, s50, 64
  buffer_load_ushort v26, v5, s[20:23], s50 offen
  buffer_load_ushort v27, v5, s[20:23], s51 offen
  s_lshl_b32 s60, s28, 2
  s_add_u32 s60, s60, s37
  s_cmp_lt_u32 s60, 720
  s_cselect_b32 s61, 0, 2130706432
  s_cselect_b32 s60, s60, 0
  s_mul_i32 s60, s60, 3
  v_lshrrev_b32 v5, 1, v1
  v_mul_u32_u24 v5, 1280, v5
  v_and_b32 v6, 1, v1
  v_lshl_add_u32 v5, v6, 4, v5
  v_add_u32 v28, s61, v5
  v_lshlrev_b32 v5, 4, v1
  v_add_u32 v30, s61, v5
  v_bfe_u32 v5, v1, 2, 2
  v_bfe_u32 v6, v1, 4, 1
  v_lshl_add_u32 v5, v6, 4, v5
  v_lshl_add_u32 v5, v3, 2, v5
  v_lshlrev_b32 v5, 5, v5
  v_and_b32 v6, 3, v1
  v_lshl_add_u32 v5, v6, 3, v5
  s_lshl_b32 s62, s37, 12
  s_add_u32 s62, s62, 49152
  v_add_u32 v29, s62, v5
  s_add_u32 s63, s60, 0
  s_mul_i32 s64, s63, 1639
  s_lshr_b32 s64, s64, 16
  s_mul_i32 s65, s64, 40
  s_sub_u32 s63, s63, s65
  s_mul_i32 s54, s64, 40960
  s_lshl_b32 s65, s63, 5
  s_add_u32 s54, s54, s65
  s_mul_i32 s65, s63, 52
  s_lshr_b32 s65, s65, 8
  s_mul_i32 s66, s65, 5
  s_sub_u32 s63, s63, s66
  s_mul_i32 s65, s65, 54
  s_add_u32 s65, s65, s64
  s_mul_i32 s65, s65, 5120
  s_lshl_b32 s63, s63, 10
  s_add_u32 s65, s65, s63
  s_add_u32 s57, s65, 7340032
  s_add_u32 s63, s60, 1
  s_mul_i32 s64, s63, 1639
  s_lshr_b32 s64, s64, 16
  s_mul_i32 s65, s64, 40
  s_sub_u32 s63, s63, s65
  s_mul_i32 s55, s64, 40960
  s_lshl_b32 s65, s63, 5
  s_add_u32 s55, s55, s65
  s_mul_i32 s65, s63, 52
  s_lshr_b32 s65, s65, 8
  s_mul_i32 s66, s65, 5
  s_sub_u32 s63, s63, s66
  s_mul_i32 s65, s65, 54
  s_add_u32 s65, s65, s64
  s_mul_i32 s65, s65, 5120
  s_lshl_b32 s63, s63, 10
  s_add_u32 s65, s65, s63
  s_add_u32 s58, s65, 7340032
  s_add_u32 s63, s60, 2
  s_mul_i32 s64, s63, 1639
  s_lshr_b32 s64, s64, 16
  s_mul_i32 s65, s64, 40
  s_sub_u32 s63, s63, s65
  s_mul_i32 s56, s64, 40960
  s_lshl_b32 s65, s63, 5
  s_add_u32 s56, s56, s65
  s_mul_i32 s65, s63, 52
  s_lshr_b32 s65, s65, 8
  s_mul_i32 s66, s65, 5
  s_sub_u32 s63, s63, s66
  s_mul_i32 s65, s65, 54
  s_add_u32 s65, s65, s64
  s_mul_i32 s65, s65, 5120
  s_lshl_b32 s63, s63, 10
  s_add_u32 s65, s65, s63
  s_add_u32 s59, s65, 7340032
  s_waitcnt vmcnt(16)
  s_barrier
  ds_read_b64_tr_b16 v[40:41], v24 offset:0
  ds_read_b64_tr_b16 v[42:43], v24 offset:1024
  ds_read_b128 v[32:35], v16 offset:0
  ds_read_b64_tr_b16 v[44:45], v25 offset:0
  ds_read_b64_tr_b16 v[46:47], v25 offset:1024
  ds_read_b128 v[36:39], v20 offset:0
  ds_read_b64_tr_b16 v[56:57], v24 offset:4096
  ds_read_b64_tr_b16 v[58:59], v24 offset:5120
  ds_read_b128 v[48:51], v17 offset:0
  ds_read_b64_tr_b16 v[60:61], v25 offset:4096
  ds_read_b64_tr_b16 v[62:63], v25 offset:5120
  ds_read_b128 v[52:55], v21 offset:0
  s_waitcnt vmcnt(14) lgkmcnt(0)
  s_barrier
  v_mfma_f32_32x32x16_bf16 v[64:79], v[40:43], v[32:35], 0
  s_mul_i32 s46, s44, 221184
  s_add_u32 m0, s42, 0
  s_nop 0
  buffer_load_dwordx4 v12, s[16:19], s46 offen lds
  ds_read_b64_tr_b16 v[136:137], v24 offset:8192
  ds_read_b64_tr_b16 v[138:139], v24 offset:9216
  v_lshlrev_b32 v174, 16, v32
  v_and_b32 v175, 0xffff0000, v32
  v_fmac_f32 v172, v174, v174
  v_fmac_f32 v173, v175, v175
  v_mfma_f32_32x32x16_bf16 v[80:95], v[40:43], v[36:39], 0
  ds_read_b128 v[128:131], v18 offset:0
  v_lshlrev_b32 v176, 16, v33
  v_and_b32 v177, 0xffff0000, v33
  v_fmac_f32 v172, v176, v176
  v_fmac_f32 v173, v177, v177
  v_mfma_f32_16x16x32_bf16 v[164:167], v[160:163], v[32:35], 0
  v_mfma_f32_32x32x16_bf16 v[96:111], v[44:47], v[32:35], 0
  buffer_load_dwordx4 v13, s[16:19], s46 offen offset:1024 lds
  ds_read_b64_tr_b16 v[140:141], v25 offset:8192
  ds_read_b64_tr_b16 v[142:143], v25 offset:9216
  v_lshlrev_b32 v174, 16, v34
  v_and_b32 v175, 0xffff0000, v34
  v_fmac_f32 v172, v174, v174
  v_fmac_f32 v173, v175, v175
  v_mfma_f32_32x32x16_bf16 v[112:127], v[44:47], v[36:39], 0
  ds_read_b128 v[132:135], v22 offset:0
  v_lshlrev_b32 v176, 16, v35
  v_and_b32 v177, 0xffff0000, v35
  v_fmac_f32 v172, v176, v176
  v_fmac_f32 v173, v177, v177
  v_mfma_f32_16x16x32_bf16 v[168:171], v[160:163], v[40:43], 0
  v_mfma_f32_32x32x16_bf16 v[64:79], v[56:59], v[48:51], v[64:79]
  ds_read_b64_tr_b16 v[152:153], v24 offset:12288
  ds_read_b64_tr_b16 v[154:155], v24 offset:13312
  v_lshlrev_b32 v174, 16, v48
  v_and_b32 v175, 0xffff0000, v48
  v_fmac_f32 v172, v174, v174
  v_fmac_f32 v173, v175, v175
  v_mfma_f32_32x32x16_bf16 v[80:95], v[56:59], v[52:55], v[80:95]
  ds_read_b128 v[144:147], v19 offset:0
  ds_read_b64_tr_b16 v[156:157], v25 offset:12288
  v_lshlrev_b32 v176, 16, v49
  v_and_b32 v177, 0xffff0000, v49
  v_fmac_f32 v172, v176, v176
  v_fmac_f32 v173, v177, v177
  v_mfma_f32_16x16x32_bf16 v[164:167], v[160:163], v[48:51], v[164:167]
  v_mfma_f32_32x32x16_bf16 v[96:111], v[60:63], v[48:51], v[96:111]
  ds_read_b64_tr_b16 v[158:159], v25 offset:13312
  ds_read_b128 v[148:151], v23 offset:0
  v_lshlrev_b32 v174, 16, v50
  v_and_b32 v175, 0xffff0000, v50
  v_fmac_f32 v172, v174, v174
  v_fmac_f32 v173, v175, v175
  v_mfma_f32_32x32x16_bf16 v[112:127], v[60:63], v[52:55], v[112:127]
  v_lshlrev_b32 v176, 16, v51
  v_and_b32 v177, 0xffff0000, v51
  v_fmac_f32 v172, v176, v176
  v_fmac_f32 v173, v177, v177
  v_mfma_f32_16x16x32_bf16 v[168:171], v[160:163], v[56:59], v[168:171]
  s_waitcnt vmcnt(10) lgkmcnt(0)
  s_barrier
  v_mfma_f32_32x32x16_bf16 v[64:79], v[136:139], v[128:131], v[64:79]
  s_mul_i32 s46, s44, 221184
  s_add_u32 s46, s46, 110592
  s_add_u32 s44, s44, 1
  s_cmp_eq_u32 s44, 10
  s_cselect_b32 s44, 0, s44
  s_add_u32 m0, s42, 8192
  s_nop 0
  buffer_load_dwordx4 v12, s[16:19], s46 offen lds
  ds_read_b64_tr_b16 v[40:41], v24 offset:16384
  ds_read_b64_tr_b16 v[42:43], v24 offset:17408
  v_lshlrev_b32 v174, 16, v128
  v_and_b32 v175, 0xffff0000, v128
  v_fmac_f32 v172, v174, v174
  v_fmac_f32 v173, v175, v175
  v_mfma_f32_32x32x16_bf16 v[80:95], v[136:139], v[132:135], v[80:95]
  ds_read_b128 v[32:35], v16 offset:16384
  v_lshlrev_b32 v176, 16, v129
  v_and_b32 v177, 0xffff0000, v129
  v_fmac_f32 v172, v176, v176
  v_fmac_f32 v173, v177, v177
  v_mfma_f32_16x16x32_bf16 v[164:167], v[160:163], v[128:131], v[164:167]
  v_mfma_f32_32x32x16_bf16 v[96:111], v[140:143], v[128:131], v[96:111]
  buffer_load_dwordx4 v13, s[16:19], s46 offen offset:1024 lds
  ds_read_b64_tr_b16 v[44:45], v25 offset:16384
  ds_read_b64_tr_b16 v[46:47], v25 offset:17408
  v_lshlrev_b32 v174, 16, v130
  v_and_b32 v175, 0xffff0000, v130
  v_fmac_f32 v172, v174, v174
  v_fmac_f32 v173, v175, v175
  v_mfma_f32_32x32x16_bf16 v[112:127], v[140:143], v[132:135], v[112:127]
  ds_read_b128 v[36:39], v20 offset:16384
  v_lshlrev_b32 v176, 16, v131
  v_and_b32 v177, 0xffff0000, v131
  v_fmac_f32 v172, v176, v176
  v_fmac_f32 v173, v177, v177
  v_mfma_f32_16x16x32_bf16 v[168:171], v[160:163], v[136:139], v[168:171]
  v_mfma_f32_32x32x16_bf16 v[64:79], v[152:155], v[144:147], v[64:79]
  s_lshl_b32 s45, s43, 7
  s_add_u32 s43, s43, 1
  s_cmp_eq_u32 s43, 10
  s_cselect_b32 s43, 0, s43
  s_add_u32 m0, s41, 0
  s_nop 0
  buffer_load_dwordx4 v8, s[8:11], s45 offen offset:0 lds
  ds_read_b64_tr_b16 v[56:57], v24 offset:20480
  ds_read_b64_tr_b16 v[58:59], v24 offset:21504
  v_lshlrev_b32 v174, 16, v144
  v_and_b32 v175, 0xffff0000, v144
  v_fmac_f32 v172, v174, v174
  v_fmac_f32 v173, v175, v175
  v_mfma_f32_32x32x16_bf16 v[80:95], v[152:155], v[148:151], v[80:95]
  ds_read_b128 v[48:51], v17 offset:16384
  ds_read_b64_tr_b16 v[60:61], v25 offset:20480
  v_lshlrev_b32 v176, 16, v145
  v_and_b32 v177, 0xffff0000, v145
  v_fmac_f32 v172, v176, v176
  v_fmac_f32 v173, v177, v177
  v_mfma_f32_16x16x32_bf16 v[164:167], v[160:163], v[144:147], v[164:167]
  v_mfma_f32_32x32x16_bf16 v[96:111], v[156:159], v[144:147], v[96:111]
  buffer_load_dwordx4 v9, s[8:11], s45 offen offset:1024 lds
  ds_read_b64_tr_b16 v[62:63], v25 offset:21504
  ds_read_b128 v[52:55], v21 offset:16384
  v_lshlrev_b32 v174, 16, v146
  v_and_b32 v175, 0xffff0000, v146
  v_fmac_f32 v172, v174, v174
  v_fmac_f32 v173, v175, v175
  v_mfma_f32_32x32x16_bf16 v[112:127], v[156:159], v[148:151], v[112:127]
  v_lshlrev_b32 v176, 16, v147
  v_and_b32 v177, 0xffff0000, v147
  v_fmac_f32 v172, v176, v176
  v_fmac_f32 v173, v177, v177
  v_mfma_f32_16x16x32_bf16 v[168:171], v[160:163], v[152:155], v[168:171]
  s_waitcnt vmcnt(12) lgkmcnt(0)
  s_barrier
  v_mfma_f32_32x32x16_bf16 v[64:79], v[40:43], v[32:35], v[64:79]
  s_mul_i32 s46, s44, 221184
  s_add_u32 m0, s42, 16384
  s_nop 0
  buffer_load_dwordx4 v12, s[16:19], s46 offen lds
  ds_read_b64_tr_b16 v[136:137], v24 offset:24576
  ds_read_b64_tr_b16 v[138:139], v24 offset:25600
  v_lshlrev_b32 v174, 16, v32
  v_and_b32 v175, 0xffff0000, v32
  v_fmac_f32 v172, v174, v174
  v_fmac_f32 v173, v175, v175
  v_mfma_f32_32x32x16_bf16 v[80:95], v[40:43], v[36:39], v[80:95]
  ds_read_b128 v[128:131], v18 offset:16384
  v_lshlrev_b32 v176, 16, v33
  v_and_b32 v177, 0xffff0000, v33
  v_fmac_f32 v172, v176, v176
  v_fmac_f32 v173, v177, v177
  v_mfma_f32_16x16x32_bf16 v[164:167], v[160:163], v[32:35], v[164:167]
  v_mfma_f32_32x32x16_bf16 v[96:111], v[44:47], v[32:35], v[96:111]
  buffer_load_dwordx4 v13, s[16:19], s46 offen offset:1024 lds
  ds_read_b64_tr_b16 v[140:141], v25 offset:24576
  ds_read_b64_tr_b16 v[142:143], v25 offset:25600
  v_lshlrev_b32 v174, 16, v34
  v_and_b32 v175, 0xffff0000, v34
  v_fmac_f32 v172, v174, v174
  v_fmac_f32 v173, v175, v175
  v_mfma_f32_32x32x16_bf16 v[112:127], v[44:47], v[36:39], v[112:127]
  ds_read_b128 v[132:135], v22 offset:16384
  v_lshlrev_b32 v176, 16, v35
  v_and_b32 v177, 0xffff0000, v35
  v_fmac_f32 v172, v176, v176
  v_fmac_f32 v173, v177, v177
  v_mfma_f32_16x16x32_bf16 v[168:171], v[160:163], v[40:43], v[168:171]
  v_mfma_f32_32x32x16_bf16 v[64:79], v[56:59], v[48:51], v[64:79]
  s_add_u32 m0, s41, 0
  s_nop 0
  buffer_load_dwordx4 v10, s[8:11], s45 offen offset:2048 lds
  ds_read_b64_tr_b16 v[152:153], v24 offset:28672
  ds_read_b64_tr_b16 v[154:155], v24 offset:29696
  v_lshlrev_b32 v174, 16, v48
  v_and_b32 v175, 0xffff0000, v48
  v_fmac_f32 v172, v174, v174
  v_fmac_f32 v173, v175, v175
  v_mfma_f32_32x32x16_bf16 v[80:95], v[56:59], v[52:55], v[80:95]
  ds_read_b128 v[144:147], v19 offset:16384
  ds_read_b64_tr_b16 v[156:157], v25 offset:28672
  v_lshlrev_b32 v176, 16, v49
  v_and_b32 v177, 0xffff0000, v49
  v_fmac_f32 v172, v176, v176
  v_fmac_f32 v173, v177, v177
  v_mfma_f32_16x16x32_bf16 v[164:167], v[160:163], v[48:51], v[164:167]
  v_mfma_f32_32x32x16_bf16 v[96:111], v[60:63], v[48:51], v[96:111]
  buffer_load_dwordx4 v11, s[8:11], s45 offen offset:3072 lds
  ds_read_b64_tr_b16 v[158:159], v25 offset:29696
  ds_read_b128 v[148:151], v23 offset:16384
  v_lshlrev_b32 v174, 16, v50
  v_and_b32 v175, 0xffff0000, v50
  v_fmac_f32 v172, v174, v174
  v_fmac_f32 v173, v175, v175
  v_mfma_f32_32x32x16_bf16 v[112:127], v[60:63], v[52:55], v[112:127]
  v_lshlrev_b32 v176, 16, v51
  v_and_b32 v177, 0xffff0000, v51
  v_fmac_f32 v172, v176, v176
  v_fmac_f32 v173, v177, v177
  v_mfma_f32_16x16x32_bf16 v[168:171], v[160:163], v[56:59], v[168:171]
  s_waitcnt vmcnt(8) lgkmcnt(0)
  s_barrier
  v_mfma_f32_32x32x16_bf16 v[64:79], v[136:139], v[128:131], v[64:79]
  s_mul_i32 s46, s44, 221184
  s_add_u32 s46, s46, 110592
  s_add_u32 s44, s44, 1
  s_cmp_eq_u32 s44, 10
  s_cselect_b32 s44, 0, s44
  s_add_u32 m0, s42, 24576
  s_nop 0
  buffer_load_dwordx4 v12, s[16:19], s46 offen lds
  ds_read_b64_tr_b16 v[40:41], v24 offset:0
  ds_read_b64_tr_b16 v[42:43], v24 offset:1024
  v_lshlrev_b32 v174, 16, v128
  v_and_b32 v175, 0xffff0000, v128
  v_fmac_f32 v172, v174, v174
  v_fmac_f32 v173, v175, v175
  v_mfma_f32_32x32x16_bf16 v[80:95], v[136:139], v[132:135], v[80:95]
  ds_read_b128 v[32:35], v16 offset:32768
  v_lshlrev_b32 v176, 16, v129
  v_and_b32 v177, 0xffff0000, v129
  v_fmac_f32 v172, v176, v176
  v_fmac_f32 v173, v177, v177
  v_mfma_f32_16x16x32_bf16 v[164:167], v[160:163], v[128:131], v[164:167]
  v_mfma_f32_32x32x16_bf16 v[96:111], v[140:143], v[128:131], v[96:111]
  buffer_load_dwordx4 v13, s[16:19], s46 offen offset:1024 lds
  ds_read_b64_tr_b16 v[44:45], v25 offset:0
  ds_read_b64_tr_b16 v[46:47], v25 offset:1024
  v_lshlrev_b32 v174, 16, v130
  v_and_b32 v175, 0xffff0000, v130
  v_fmac_f32 v172, v174, v174
  v_fmac_f32 v173, v175, v175
  v_mfma_f32_32x32x16_bf16 v[112:127], v[140:143], v[132:135], v[112:127]
  ds_read_b128 v[36:39], v20 offset:32768
  v_lshlrev_b32 v176, 16, v131
  v_and_b32 v177, 0xffff0000, v131
  v_fmac_f32 v172, v176, v176
  v_fmac_f32 v173, v177, v177
  v_mfma_f32_16x16x32_bf16 v[168:171], v[160:163], v[136:139], v[168:171]
  v_mfma_f32_32x32x16_bf16 v[64:79], v[152:155], v[144:147], v[64:79]
  s_lshl_b32 s45, s43, 7
  s_add_u32 s43, s43, 1
  s_cmp_eq_u32 s43, 10
  s_cselect_b32 s43, 0, s43
  s_add_u32 m0, s41, 16384
  s_nop 0
  buffer_load_dwordx4 v8, s[8:11], s45 offen offset:0 lds
  ds_read_b64_tr_b16 v[56:57], v24 offset:4096
  ds_read_b64_tr_b16 v[58:59], v24 offset:5120
  v_lshlrev_b32 v174, 16, v144
  v_and_b32 v175, 0xffff0000, v144
  v_fmac_f32 v172, v174, v174
  v_fmac_f32 v173, v175, v175
  v_mfma_f32_32x32x16_bf16 v[80:95], v[152:155], v[148:151], v[80:95]
  ds_read_b128 v[48:51], v17 offset:32768
  ds_read_b64_tr_b16 v[60:61], v25 offset:4096
  v_lshlrev_b32 v176, 16, v145
  v_and_b32 v177, 0xffff0000, v145
  v_fmac_f32 v172, v176, v176
  v_fmac_f32 v173, v177, v177
  v_mfma_f32_16x16x32_bf16 v[164:167], v[160:163], v[144:147], v[164:167]
  v_mfma_f32_32x32x16_bf16 v[96:111], v[156:159], v[144:147], v[96:111]
  buffer_load_dwordx4 v9, s[8:11], s45 offen offset:1024 lds
  ds_read_b64_tr_b16 v[62:63], v25 offset:5120
  ds_read_b128 v[52:55], v21 offset:32768
  v_lshlrev_b32 v174, 16, v146
  v_and_b32 v175, 0xffff0000, v146
  v_fmac_f32 v172, v174, v174
  v_fmac_f32 v173, v175, v175
  v_mfma_f32_32x32x16_bf16 v[112:127], v[156:159], v[148:151], v[112:127]
  v_lshlrev_b32 v176, 16, v147
  v_and_b32 v177, 0xffff0000, v147
  v_fmac_f32 v172, v176, v176
  v_fmac_f32 v173, v177, v177
  v_mfma_f32_16x16x32_bf16 v[168:171], v[160:163], v[152:155], v[168:171]
  s_waitcnt vmcnt(10) lgkmcnt(0)
  s_barrier
  v_mfma_f32_32x32x16_bf16 v[64:79], v[40:43], v[32:35], v[64:79]
  s_mul_i32 s46, s44, 221184
  s_add_u32 m0, s42, 0
  s_nop 0
  buffer_load_dwordx4 v12, s[16:19], s46 offen lds
  ds_read_b64_tr_b16 v[136:137], v24 offset:8192
  ds_read_b64_tr_b16 v[138:139], v24 offset:9216
  v_lshlrev_b32 v174, 16, v32
  v_and_b32 v175, 0xffff0000, v32
  v_fmac_f32 v172, v174, v174
  v_fmac_f32 v173, v175, v175
  v_mfma_f32_32x32x16_bf16 v[80:95], v[40:43], v[36:39], v[80:95]
  ds_read_b128 v[128:131], v18 offset:32768
  v_lshlrev_b32 v176, 16, v33
  v_and_b32 v177, 0xffff0000, v33
  v_fmac_f32 v172, v176, v176
  v_fmac_f32 v173, v177, v177
  v_mfma_f32_16x16x32_bf16 v[164:167], v[160:163], v[32:35], v[164:167]
  v_mfma_f32_32x32x16_bf16 v[96:111], v[44:47], v[32:35], v[96:111]
  buffer_load_dwordx4 v13, s[16:19], s46 offen offset:1024 lds
  ds_read_b64_tr_b16 v[140:141], v25 offset:8192
  ds_read_b64_tr_b16 v[142:143], v25 offset:9216
  v_lshlrev_b32 v174, 16, v34
  v_and_b32 v175, 0xffff0000, v34
  v_fmac_f32 v172, v174, v174
  v_fmac_f32 v173, v175, v175
  v_mfma_f32_32x32x16_bf16 v[112:127], v[44:47], v[36:39], v[112:127]
  ds_read_b128 v[132:135], v22 offset:32768
  v_lshlrev_b32 v176, 16, v35
  v_and_b32 v177, 0xffff0000, v35
  v_fmac_f32 v172, v176, v176
  v_fmac_f32 v173, v177, v177
  v_mfma_f32_16x16x32_bf16 v[168:171], v[160:163], v[40:43], v[168:171]
  v_mfma_f32_32x32x16_bf16 v[64:79], v[56:59], v[48:51], v[64:79]
  s_add_u32 m0, s41, 16384
  s_nop 0
  buffer_load_dwordx4 v10, s[8:11], s45 offen offset:2048 lds
  ds_read_b64_tr_b16 v[152:153], v24 offset:12288
  ds_read_b64_tr_b16 v[154:155], v24 offset:13312
  v_lshlrev_b32 v174, 16, v48
  v_and_b32 v175, 0xffff0000, v48
  v_fmac_f32 v172, v174, v174
  v_fmac_f32 v173, v175, v175
  v_mfma_f32_32x32x16_bf16 v[80:95], v[56:59], v[52:55], v[80:95]
  ds_read_b128 v[144:147], v19 offset:32768
  ds_read_b64_tr_b16 v[156:157], v25 offset:12288
  v_lshlrev_b32 v176, 16, v49
  v_and_b32 v177, 0xffff0000, v49
  v_fmac_f32 v172, v176, v176
  v_fmac_f32 v173, v177, v177
  v_mfma_f32_16x16x32_bf16 v[164:167], v[160:163], v[48:51], v[164:167]
  v_mfma_f32_32x32x16_bf16 v[96:111], v[60:63], v[48:51], v[96:111]
  buffer_load_dwordx4 v11, s[8:11], s45 offen offset:3072 lds
  ds_read_b64_tr_b16 v[158:159], v25 offset:13312
  ds_read_b128 v[148:151], v23 offset:32768
  v_lshlrev_b32 v174, 16, v50
  v_and_b32 v175, 0xffff0000, v50
  v_fmac_f32 v172, v174, v174
  v_fmac_f32 v173, v175, v175
  v_mfma_f32_32x32x16_bf16 v[112:127], v[60:63], v[52:55], v[112:127]
  v_lshlrev_b32 v176, 16, v51
  v_and_b32 v177, 0xffff0000, v51
  v_fmac_f32 v172, v176, v176
  v_fmac_f32 v173, v177, v177
  v_mfma_f32_16x16x32_bf16 v[168:171], v[160:163], v[56:59], v[168:171]
  s_waitcnt vmcnt(8) lgkmcnt(0)
  s_barrier
  v_mfma_f32_32x32x16_bf16 v[64:79], v[136:139], v[128:131], v[64:79]
  s_mul_i32 s46, s44, 221184
  s_add_u32 s46, s46, 110592
  s_add_u32 s44, s44, 1
  s_cmp_eq_u32 s44, 10
  s_cselect_b32 s44, 0, s44
  s_add_u32 m0, s42, 8192
  s_nop 0
  buffer_load_dwordx4 v12, s[16:19], s46 offen lds
  ds_read_b64_tr_b16 v[40:41], v24 offset:16384
  ds_read_b64_tr_b16 v[42:43], v24 offset:17408
  v_lshlrev_b32 v174, 16, v128
  v_and_b32 v175, 0xffff0000, v128
  v_fmac_f32 v172, v174, v174
  v_fmac_f32 v173, v175, v175
  v_mfma_f32_32x32x16_bf16 v[80:95], v[136:139], v[132:135], v[80:95]
  ds_read_b128 v[32:35], v16 offset:0
  v_lshlrev_b32 v176, 16, v129
  v_and_b32 v177, 0xffff0000, v129
  v_fmac_f32 v172, v176, v176
  v_fmac_f32 v173, v177, v177
  v_mfma_f32_16x16x32_bf16 v[164:167], v[160:163], v[128:131], v[164:167]
  v_mfma_f32_32x32x16_bf16 v[96:111], v[140:143], v[128:131], v[96:111]
  buffer_load_dwordx4 v13, s[16:19], s46 offen offset:1024 lds
  ds_read_b64_tr_b16 v[44:45], v25 offset:16384
  ds_read_b64_tr_b16 v[46:47], v25 offset:17408
  v_lshlrev_b32 v174, 16, v130
  v_and_b32 v175, 0xffff0000, v130
  v_fmac_f32 v172, v174, v174
  v_fmac_f32 v173, v175, v175
  v_mfma_f32_32x32x16_bf16 v[112:127], v[140:143], v[132:135], v[112:127]
  ds_read_b128 v[36:39], v20 offset:0
  v_lshlrev_b32 v176, 16, v131
  v_and_b32 v177, 0xffff0000, v131
  v_fmac_f32 v172, v176, v176
  v_fmac_f32 v173, v177, v177
  v_mfma_f32_16x16x32_bf16 v[168:171], v[160:163], v[136:139], v[168:171]
  v_mfma_f32_32x32x16_bf16 v[64:79], v[152:155], v[144:147], v[64:79]
  s_lshl_b32 s45, s43, 7
  s_add_u32 s43, s43, 1
  s_cmp_eq_u32 s43, 10
  s_cselect_b32 s43, 0, s43
  s_add_u32 m0, s41, 32768
  s_nop 0
  buffer_load_dwordx4 v8, s[8:11], s45 offen offset:0 lds
  ds_read_b64_tr_b16 v[56:57], v24 offset:20480
  ds_read_b64_tr_b16 v[58:59], v24 offset:21504
  v_lshlrev_b32 v174, 16, v144
  v_and_b32 v175, 0xffff0000, v144
  v_fmac_f32 v172, v174, v174
  v_fmac_f32 v173, v175, v175
  v_mfma_f32_32x32x16_bf16 v[80:95], v[152:155], v[148:151], v[80:95]
  ds_read_b128 v[48:51], v17 offset:0
  ds_read_b64_tr_b16 v[60:61], v25 offset:20480
  v_lshlrev_b32 v176, 16, v145
  v_and_b32 v177, 0xffff0000, v145
  v_fmac_f32 v172, v176, v176
  v_fmac_f32 v173, v177, v177
  v_mfma_f32_16x16x32_bf16 v[164:167], v[160:163], v[144:147], v[164:167]
  v_mfma_f32_32x32x16_bf16 v[96:111], v[156:159], v[144:147], v[96:111]
  buffer_load_dwordx4 v9, s[8:11], s45 offen offset:1024 lds
  ds_read_b64_tr_b16 v[62:63], v25 offset:21504
  ds_read_b128 v[52:55], v21 offset:0
  v_lshlrev_b32 v174, 16, v146
  v_and_b32 v175, 0xffff0000, v146
  v_fmac_f32 v172, v174, v174
  v_fmac_f32 v173, v175, v175
  v_mfma_f32_32x32x16_bf16 v[112:127], v[156:159], v[148:151], v[112:127]
  v_lshlrev_b32 v176, 16, v147
  v_and_b32 v177, 0xffff0000, v147
  v_fmac_f32 v172, v176, v176
  v_fmac_f32 v173, v177, v177
  v_mfma_f32_16x16x32_bf16 v[168:171], v[160:163], v[152:155], v[168:171]
  s_waitcnt vmcnt(10) lgkmcnt(0)
  s_barrier
  v_mfma_f32_32x32x16_bf16 v[64:79], v[40:43], v[32:35], v[64:79]
  s_mul_i32 s46, s44, 221184
  s_add_u32 m0, s42, 16384
  s_nop 0
  buffer_load_dwordx4 v12, s[16:19], s46 offen lds
  ds_read_b64_tr_b16 v[136:137], v24 offset:24576
  ds_read_b64_tr_b16 v[138:139], v24 offset:25600
  v_lshlrev_b32 v174, 16, v32
  v_and_b32 v175, 0xffff0000, v32
  v_fmac_f32 v172, v174, v174
  v_fmac_f32 v173, v175, v175
  v_mfma_f32_32x32x16_bf16 v[80:95], v[40:43], v[36:39], v[80:95]
  ds_read_b128 v[128:131], v18 offset:0
  v_lshlrev_b32 v176, 16, v33
  v_and_b32 v177, 0xffff0000, v33
  v_fmac_f32 v172, v176, v176
  v_fmac_f32 v173, v177, v177
  v_mfma_f32_16x16x32_bf16 v[164:167], v[160:163], v[32:35], v[164:167]
  v_mfma_f32_32x32x16_bf16 v[96:111], v[44:47], v[32:35], v[96:111]
  buffer_load_dwordx4 v13, s[16:19], s46 offen offset:1024 lds
  ds_read_b64_tr_b16 v[140:141], v25 offset:24576
  ds_read_b64_tr_b16 v[142:143], v25 offset:25600
  v_lshlrev_b32 v174, 16, v34
  v_and_b32 v175, 0xffff0000, v34
  v_fmac_f32 v172, v174, v174
  v_fmac_f32 v173, v175, v175
  v_mfma_f32_32x32x16_bf16 v[112:127], v[44:47], v[36:39], v[112:127]
  ds_read_b128 v[132:135], v22 offset:0
  v_lshlrev_b32 v176, 16, v35
  v_and_b32 v177, 0xffff0000, v35
  v_fmac_f32 v172, v176, v176
  v_fmac_f32 v173, v177, v177
  v_mfma_f32_16x16x32_bf16 v[168:171], v[160:163], v[40:43], v[168:171]
  v_mfma_f32_32x32x16_bf16 v[64:79], v[56:59], v[48:51], v[64:79]
  s_add_u32 m0, s41, 32768
  s_nop 0
  buffer_load_dwordx4 v10, s[8:11], s45 offen offset:2048 lds
  ds_read_b64_tr_b16 v[152:153], v24 offset:28672
  ds_read_b64_tr_b16 v[154:155], v24 offset:29696
  v_lshlrev_b32 v174, 16, v48
  v_and_b32 v175, 0xffff0000, v48
  v_fmac_f32 v172, v174, v174
  v_fmac_f32 v173, v175, v175
  v_mfma_f32_32x32x16_bf16 v[80:95], v[56:59], v[52:55], v[80:95]
  ds_read_b128 v[144:147], v19 offset:0
  ds_read_b64_tr_b16 v[156:157], v25 offset:28672
  v_lshlrev_b32 v176, 16, v49
  v_and_b32 v177, 0xffff0000, v49
  v_fmac_f32 v172, v176, v176
  v_fmac_f32 v173, v177, v177
  v_mfma_f32_16x16x32_bf16 v[164:167], v[160:163], v[48:51], v[164:167]
  v_mfma_f32_32x32x16_bf16 v[96:111], v[60:63], v[48:51], v[96:111]
  buffer_load_dwordx4 v11, s[8:11], s45 offen offset:3072 lds
  ds_read_b64_tr_b16 v[158:159], v25 offset:29696
  ds_read_b128 v[148:151], v23 offset:0
  v_lshlrev_b32 v174, 16, v50
  v_and_b32 v175, 0xffff0000, v50
  v_fmac_f32 v172, v174, v174
  v_fmac_f32 v173, v175, v175
  v_mfma_f32_32x32x16_bf16 v[112:127], v[60:63], v[52:55], v[112:127]
  v_lshlrev_b32 v176, 16, v51
  v_and_b32 v177, 0xffff0000, v51
  v_fmac_f32 v172, v176, v176
  v_fmac_f32 v173, v177, v177
  v_mfma_f32_16x16x32_bf16 v[168:171], v[160:163], v[56:59], v[168:171]
  s_waitcnt vmcnt(8) lgkmcnt(0)
  s_barrier
  v_mfma_f32_32x32x16_bf16 v[64:79], v[136:139], v[128:131], v[64:79]
  s_mul_i32 s46, s44, 221184
  s_add_u32 s46, s46, 110592
  s_add_u32 s44, s44, 1
  s_cmp_eq_u32 s44, 10
  s_cselect_b32 s44, 0, s44
  s_add_u32 m0, s42, 24576
  s_nop 0
  buffer_load_dwordx4 v12, s[16:19], s46 offen lds
  ds_read_b64_tr_b16 v[40:41], v24 offset:0
  ds_read_b64_tr_b16 v[42:43], v24 offset:1024
  v_lshlrev_b32 v174, 16, v128
  v_and_b32 v175, 0xffff0000, v128
  v_fmac_f32 v172, v174, v174
  v_fmac_f32 v173, v175, v175
  v_mfma_f32_32x32x16_bf16 v[80:95], v[136:139], v[132:135], v[80:95]
  ds_read_b128 v[32:35], v16 offset:16384
  v_lshlrev_b32 v176, 16, v129
  v_and_b32 v177, 0xffff0000, v129
  v_fmac_f32 v172, v176, v176
  v_fmac_f32 v173, v177, v177
  v_mfma_f32_16x16x32_bf16 v[164:167], v[160:163], v[128:131], v[164:167]
  v_mfma_f32_32x32x16_bf16 v[96:111], v[140:143], v[128:131], v[96:111]
  buffer_load_dwordx4 v13, s[16:19], s46 offen offset:1024 lds
  ds_read_b64_tr_b16 v[44:45], v25 offset:0
  ds_read_b64_tr_b16 v[46:47], v25 offset:1024
  v_lshlrev_b32 v174, 16, v130
  v_and_b32 v175, 0xffff0000, v130
  v_fmac_f32 v172, v174, v174
  v_fmac_f32 v173, v175, v175
  v_mfma_f32_32x32x16_bf16 v[112:127], v[140:143], v[132:135], v[112:127]
  ds_read_b128 v[36:39], v20 offset:16384
  v_lshlrev_b32 v176, 16, v131
  v_and_b32 v177, 0xffff0000, v131
  v_fmac_f32 v172, v176, v176
  v_fmac_f32 v173, v177, v177
  v_mfma_f32_16x16x32_bf16 v[168:171], v[160:163], v[136:139], v[168:171]
  v_mfma_f32_32x32x16_bf16 v[64:79], v[152:155], v[144:147], v[64:79]
  s_lshl_b32 s45, s43, 7
  s_add_u32 s43, s43, 1
  s_cmp_eq_u32 s43, 10
  s_cselect_b32 s43, 0, s43
  s_add_u32 m0, s41, 0
  s_nop 0
  buffer_load_dwordx4 v8, s[8:11], s45 offen offset:0 lds
  ds_read_b64_tr_b16 v[56:57], v24 offset:4096
  ds_read_b64_tr_b16 v[58:59], v24 offset:5120
  v_lshlrev_b32 v174, 16, v144
  v_and_b32 v175, 0xffff0000, v144
  v_fmac_f32 v172, v174, v174
  v_fmac_f32 v173, v175, v175
  v_mfma_f32_32x32x16_bf16 v[80:95], v[152:155], v[148:151], v[80:95]
  ds_read_b128 v[48:51], v17 offset:16384
  ds_read_b64_tr_b16 v[60:61], v25 offset:4096
  v_lshlrev_b32 v176, 16, v145
  v_and_b32 v177, 0xffff0000, v145
  v_fmac_f32 v172, v176, v176
  v_fmac_f32 v173, v177, v177
  v_mfma_f32_16x16x32_bf16 v[164:167], v[160:163], v[144:147], v[164:167]
  v_mfma_f32_32x32x16_bf16 v[96:111], v[156:159], v[144:147], v[96:111]
  buffer_load_dwordx4 v9, s[8:11], s45 offen offset:1024 lds
  ds_read_b64_tr_b16 v[62:63], v25 offset:5120
  ds_read_b128 v[52:55], v21 offset:16384
  v_lshlrev_b32 v174, 16, v146
  v_and_b32 v175, 0xffff0000, v146
  v_fmac_f32 v172, v174, v174
  v_fmac_f32 v173, v175, v175
  v_mfma_f32_32x32x16_bf16 v[112:127], v[156:159], v[148:151], v[112:127]
  v_lshlrev_b32 v176, 16, v147
  v_and_b32 v177, 0xffff0000, v147
  v_fmac_f32 v172, v176, v176
  v_fmac_f32 v173, v177, v177
  v_mfma_f32_16x16x32_bf16 v[168:171], v[160:163], v[152:155], v[168:171]
  s_waitcnt vmcnt(10) lgkmcnt(0)
  s_barrier
  v_mfma_f32_32x32x16_bf16 v[64:79], v[40:43], v[32:35], v[64:79]
  s_mul_i32 s46, s44, 221184
  s_add_u32 m0, s42, 0
  s_nop 0
  buffer_load_dwordx4 v12, s[16:19], s46 offen lds
  ds_read_b64_tr_b16 v[136:137], v24 offset:8192
  ds_read_b64_tr_b16 v[138:139], v24 offset:9216
  v_lshlrev_b32 v174, 16, v32
  v_and_b32 v175, 0xffff0000, v32
  v_fmac_f32 v172, v174, v174
  v_fmac_f32 v173, v175, v175
  v_mfma_f32_32x32x16_bf16 v[80:95], v[40:43], v[36:39], v[80:95]
  ds_read_b128 v[128:131], v18 offset:16384
  v_lshlrev_b32 v176, 16, v33
  v_and_b32 v177, 0xffff0000, v33
  v_fmac_f32 v172, v176, v176
  v_fmac_f32 v173, v177, v177
  v_mfma_f32_16x16x32_bf16 v[164:167], v[160:163], v[32:35], v[164:167]
  v_mfma_f32_32x32x16_bf16 v[96:111], v[44:47], v[32:35], v[96:111]
  buffer_load_dwordx4 v13, s[16:19], s46 offen offset:1024 lds
  ds_read_b64_tr_b16 v[140:141], v25 offset:8192
  ds_read_b64_tr_b16 v[142:143], v25 offset:9216
  v_lshlrev_b32 v174, 16, v34
  v_and_b32 v175, 0xffff0000, v34
  v_fmac_f32 v172, v174, v174
  v_fmac_f32 v173, v175, v175
  v_mfma_f32_32x32x16_bf16 v[112:127], v[44:47], v[36:39], v[112:127]
  ds_read_b128 v[132:135], v22 offset:16384
  v_lshlrev_b32 v176, 16, v35
  v_and_b32 v177, 0xffff0000, v35
  v_fmac_f32 v172, v176, v176
  v_fmac_f32 v173, v177, v177
  v_mfma_f32_16x16x32_bf16 v[168:171], v[160:163], v[40:43], v[168:171]
  v_mfma_f32_32x32x16_bf16 v[64:79], v[56:59], v[48:51], v[64:79]
  s_add_u32 m0, s41, 0
  s_nop 0
  buffer_load_dwordx4 v10, s[8:11], s45 offen offset:2048 lds
  ds_read_b64_tr_b16 v[152:153], v24 offset:12288
  ds_read_b64_tr_b16 v[154:155], v24 offset:13312
  v_lshlrev_b32 v174, 16, v48
  v_and_b32 v175, 0xffff0000, v48
  v_fmac_f32 v172, v174, v174
  v_fmac_f32 v173, v175, v175
  v_mfma_f32_32x32x16_bf16 v[80:95], v[56:59], v[52:55], v[80:95]
  ds_read_b128 v[144:147], v19 offset:16384
  ds_read_b64_tr_b16 v[156:157], v25 offset:12288
  v_lshlrev_b32 v176, 16, v49
  v_and_b32 v177, 0xffff0000, v49
  v_fmac_f32 v172, v176, v176
  v_fmac_f32 v173, v177, v177
  v_mfma_f32_16x16x32_bf16 v[164:167], v[160:163], v[48:51], v[164:167]
  v_mfma_f32_32x32x16_bf16 v[96:111], v[60:63], v[48:51], v[96:111]
  buffer_load_dwordx4 v11, s[8:11], s45 offen offset:3072 lds
  ds_read_b64_tr_b16 v[158:159], v25 offset:13312
  ds_read_b128 v[148:151], v23 offset:16384
  v_lshlrev_b32 v174, 16, v50
  v_and_b32 v175, 0xffff0000, v50
  v_fmac_f32 v172, v174, v174
  v_fmac_f32 v173, v175, v175
  v_mfma_f32_32x32x16_bf16 v[112:127], v[60:63], v[52:55], v[112:127]
  v_lshlrev_b32 v176, 16, v51
  v_and_b32 v177, 0xffff0000, v51
  v_fmac_f32 v172, v176, v176
  v_fmac_f32 v173, v177, v177
  v_mfma_f32_16x16x32_bf16 v[168:171], v[160:163], v[56:59], v[168:171]
  s_waitcnt vmcnt(8) lgkmcnt(0)
  s_barrier
  v_mfma_f32_32x32x16_bf16 v[64:79], v[136:139], v[128:131], v[64:79]
  s_mul_i32 s46, s44, 221184
  s_add_u32 s46, s46, 110592
  s_add_u32 s44, s44, 1
  s_cmp_eq_u32 s44, 10
  s_cselect_b32 s44, 0, s44
  s_add_u32 m0, s42, 8192
  s_nop 0
  buffer_load_dwordx4 v12, s[16:19], s46 offen lds
  ds_read_b64_tr_b16 v[40:41], v24 offset:16384
  ds_read_b64_tr_b16 v[42:43], v24 offset:17408
  v_lshlrev_b32 v174, 16, v128
  v_and_b32 v175, 0xffff0000, v128
  v_fmac_f32 v172, v174, v174
  v_fmac_f32 v173, v175, v175
  v_mfma_f32_32x32x16_bf16 v[80:95], v[136:139], v[132:135], v[80:95]
  ds_read_b128 v[32:35], v16 offset:32768
  v_lshlrev_b32 v176, 16, v129
  v_and_b32 v177, 0xffff0000, v129
  v_fmac_f32 v172, v176, v176
  v_fmac_f32 v173, v177, v177
  v_mfma_f32_16x16x32_bf16 v[164:167], v[160:163], v[128:131], v[164:167]
  v_mfma_f32_32x32x16_bf16 v[96:111], v[140:143], v[128:131], v[96:111]
  buffer_load_dwordx4 v13, s[16:19], s46 offen offset:1024 lds
  ds_read_b64_tr_b16 v[44:45], v25 offset:16384
  ds_read_b64_tr_b16 v[46:47], v25 offset:17408
  v_lshlrev_b32 v174, 16, v130
  v_and_b32 v175, 0xffff0000, v130
  v_fmac_f32 v172, v174, v174
  v_fmac_f32 v173, v175, v175
  v_mfma_f32_32x32x16_bf16 v[112:127], v[140:143], v[132:135], v[112:127]
  ds_read_b128 v[36:39], v20 offset:32768
  v_lshlrev_b32 v176, 16, v131
  v_and_b32 v177, 0xffff0000, v131
  v_fmac_f32 v172, v176, v176
  v_fmac_f32 v173, v177, v177
  v_mfma_f32_16x16x32_bf16 v[168:171], v[160:163], v[136:139], v[168:171]
  v_mfma_f32_32x32x16_bf16 v[64:79], v[152:155], v[144:147], v[64:79]
  s_lshl_b32 s45, s43, 7
  s_add_u32 s43, s43, 1
  s_cmp_eq_u32 s43, 10
  s_cselect_b32 s43, 0, s43
  s_add_u32 m0, s41, 16384
  s_nop 0
  buffer_load_dwordx4 v8, s[8:11], s45 offen offset:0 lds
  ds_read_b64_tr_b16 v[56:57], v24 offset:20480
  ds_read_b64_tr_b16 v[58:59], v24 offset:21504
  v_lshlrev_b32 v174, 16, v144
  v_and_b32 v175, 0xffff0000, v144
  v_fmac_f32 v172, v174, v174
  v_fmac_f32 v173, v175, v175
  v_mfma_f32_32x32x16_bf16 v[80:95], v[152:155], v[148:151], v[80:95]
  ds_read_b128 v[48:51], v17 offset:32768
  ds_read_b64_tr_b16 v[60:61], v25 offset:20480
  v_lshlrev_b32 v176, 16, v145
  v_and_b32 v177, 0xffff0000, v145
  v_fmac_f32 v172, v176, v176
  v_fmac_f32 v173, v177, v177
  v_mfma_f32_16x16x32_bf16 v[164:167], v[160:163], v[144:147], v[164:167]
  v_mfma_f32_32x32x16_bf16 v[96:111], v[156:159], v[144:147], v[96:111]
  buffer_load_dwordx4 v9, s[8:11], s45 offen offset:1024 lds
  ds_read_b64_tr_b16 v[62:63], v25 offset:21504
  ds_read_b128 v[52:55], v21 offset:32768
  v_lshlrev_b32 v174, 16, v146
  v_and_b32 v175, 0xffff0000, v146
  v_fmac_f32 v172, v174, v174
  v_fmac_f32 v173, v175, v175
  v_mfma_f32_32x32x16_bf16 v[112:127], v[156:159], v[148:151], v[112:127]
  v_lshlrev_b32 v176, 16, v147
  v_and_b32 v177, 0xffff0000, v147
  v_fmac_f32 v172, v176, v176
  v_fmac_f32 v173, v177, v177
  v_mfma_f32_16x16x32_bf16 v[168:171], v[160:163], v[152:155], v[168:171]
  s_waitcnt vmcnt(10) lgkmcnt(0)
  s_barrier
  v_mfma_f32_32x32x16_bf16 v[64:79], v[40:43], v[32:35], v[64:79]
  s_mul_i32 s46, s44, 221184
  s_add_u32 m0, s42, 16384
  s_nop 0
  buffer_load_dwordx4 v12, s[16:19], s46 offen lds
  ds_read_b64_tr_b16 v[136:137], v24 offset:24576
  ds_read_b64_tr_b16 v[138:139], v24 offset:25600
  v_lshlrev_b32 v174, 16, v32
  v_and_b32 v175, 0xffff0000, v32
  v_fmac_f32 v172, v174, v174
  v_fmac_f32 v173, v175, v175
  v_mfma_f32_32x32x16_bf16 v[80:95], v[40:43], v[36:39], v[80:95]
  ds_read_b128 v[128:131], v18 offset:32768
  v_lshlrev_b32 v176, 16, v33
  v_and_b32 v177, 0xffff0000, v33
  v_fmac_f32 v172, v176, v176
  v_fmac_f32 v173, v177, v177
  v_mfma_f32_16x16x32_bf16 v[164:167], v[160:163], v[32:35], v[164:167]
  v_mfma_f32_32x32x16_bf16 v[96:111], v[44:47], v[32:35], v[96:111]
  buffer_load_dwordx4 v13, s[16:19], s46 offen offset:1024 lds
  ds_read_b64_tr_b16 v[140:141], v25 offset:24576
  ds_read_b64_tr_b16 v[142:143], v25 offset:25600
  v_lshlrev_b32 v174, 16, v34
  v_and_b32 v175, 0xffff0000, v34
  v_fmac_f32 v172, v174, v174
  v_fmac_f32 v173, v175, v175
  v_mfma_f32_32x32x16_bf16 v[112:127], v[44:47], v[36:39], v[112:127]
  ds_read_b128 v[132:135], v22 offset:32768
  v_lshlrev_b32 v176, 16, v35
  v_and_b32 v177, 0xffff0000, v35
  v_fmac_f32 v172, v176, v176
  v_fmac_f32 v173, v177, v177
  v_mfma_f32_16x16x32_bf16 v[168:171], v[160:163], v[40:43], v[168:171]
  v_mfma_f32_32x32x16_bf16 v[64:79], v[56:59], v[48:51], v[64:79]
  s_add_u32 m0, s41, 16384
  s_nop 0
  buffer_load_dwordx4 v10, s[8:11], s45 offen offset:2048 lds
  ds_read_b64_tr_b16 v[152:153], v24 offset:28672
  ds_read_b64_tr_b16 v[154:155], v24 offset:29696
  v_lshlrev_b32 v174, 16, v48
  v_and_b32 v175, 0xffff0000, v48
  v_fmac_f32 v172, v174, v174
  v_fmac_f32 v173, v175, v175
  v_mfma_f32_32x32x16_bf16 v[80:95], v[56:59], v[52:55], v[80:95]
  ds_read_b128 v[144:147], v19 offset:32768
  ds_read_b64_tr_b16 v[156:157], v25 offset:28672
  v_lshlrev_b32 v176, 16, v49
  v_and_b32 v177, 0xffff0000, v49
  v_fmac_f32 v172, v176, v176
  v_fmac_f32 v173, v177, v177
  v_mfma_f32_16x16x32_bf16 v[164:167], v[160:163], v[48:51], v[164:167]
  v_mfma_f32_32x32x16_bf16 v[96:111], v[60:63], v[48:51], v[96:111]
  buffer_load_dwordx4 v11, s[8:11], s45 offen offset:3072 lds
  ds_read_b64_tr_b16 v[158:159], v25 offset:29696
  ds_read_b128 v[148:151], v23 offset:32768
  v_lshlrev_b32 v174, 16, v50
  v_and_b32 v175, 0xffff0000, v50
  v_fmac_f32 v172, v174, v174
  v_fmac_f32 v173, v175, v175
  v_mfma_f32_32x32x16_bf16 v[112:127], v[60:63], v[52:55], v[112:127]
  v_lshlrev_b32 v176, 16, v51
  v_and_b32 v177, 0xffff0000, v51
  v_fmac_f32 v172, v176, v176
  v_fmac_f32 v173, v177, v177
  v_mfma_f32_16x16x32_bf16 v[168:171], v[160:163], v[56:59], v[168:171]
  s_waitcnt vmcnt(8) lgkmcnt(0)
  s_barrier
  v_mfma_f32_32x32x16_bf16 v[64:79], v[136:139], v[128:131], v[64:79]
  s_mul_i32 s46, s44, 221184
  s_add_u32 s46, s46, 110592
  s_add_u32 s44, s44, 1
  s_cmp_eq_u32 s44, 10
  s_cselect_b32 s44, 0, s44
  s_add_u32 m0, s42, 24576
  s_nop 0
  buffer_load_dwordx4 v12, s[16:19], s46 offen lds
  ds_read_b64_tr_b16 v[40:41], v24 offset:0
  ds_read_b64_tr_b16 v[42:43], v24 offset:1024
  v_lshlrev_b32 v174, 16, v128
  v_and_b32 v175, 0xffff0000, v128
  v_fmac_f32 v172, v174, v174
  v_fmac_f32 v173, v175, v175
  v_mfma_f32_32x32x16_bf16 v[80:95], v[136:139], v[132:135], v[80:95]
  ds_read_b128 v[32:35], v16 offset:0
  v_lshlrev_b32 v176, 16, v129
  v_and_b32 v177, 0xffff0000, v129
  v_fmac_f32 v172, v176, v176
  v_fmac_f32 v173, v177, v177
  v_mfma_f32_16x16x32_bf16 v[164:167], v[160:163], v[128:131], v[164:167]
  v_mfma_f32_32x32x16_bf16 v[96:111], v[140:143], v[128:131], v[96:111]
  buffer_load_dwordx4 v13, s[16:19], s46 offen offset:1024 lds
  ds_read_b64_tr_b16 v[44:45], v25 offset:0
  ds_read_b64_tr_b16 v[46:47], v25 offset:1024
  v_lshlrev_b32 v174, 16, v130
  v_and_b32 v175, 0xffff0000, v130
  v_fmac_f32 v172, v174, v174
  v_fmac_f32 v173, v175, v175
  v_mfma_f32_32x32x16_bf16 v[112:127], v[140:143], v[132:135], v[112:127]
  ds_read_b128 v[36:39], v20 offset:0
  v_lshlrev_b32 v176, 16, v131
  v_and_b32 v177, 0xffff0000, v131
  v_fmac_f32 v172, v176, v176
  v_fmac_f32 v173, v177, v177
  v_mfma_f32_16x16x32_bf16 v[168:171], v[160:163], v[136:139], v[168:171]
  v_mfma_f32_32x32x16_bf16 v[64:79], v[152:155], v[144:147], v[64:79]
  s_lshl_b32 s45, s43, 7
  s_add_u32 s43, s43, 1
  s_cmp_eq_u32 s43, 10
  s_cselect_b32 s43, 0, s43
  s_add_u32 m0, s41, 32768
  s_nop 0
  buffer_load_dwordx4 v8, s[8:11], s45 offen offset:0 lds
  ds_read_b64_tr_b16 v[56:57], v24 offset:4096
  ds_read_b64_tr_b16 v[58:59], v24 offset:5120
  v_lshlrev_b32 v174, 16, v144
  v_and_b32 v175, 0xffff0000, v144
  v_fmac_f32 v172, v174, v174
  v_fmac_f32 v173, v175, v175
  v_mfma_f32_32x32x16_bf16 v[80:95], v[152:155], v[148:151], v[80:95]
  ds_read_b128 v[48:51], v17 offset:0
  ds_read_b64_tr_b16 v[60:61], v25 offset:4096
  v_lshlrev_b32 v176, 16, v145
  v_and_b32 v177, 0xffff0000, v145
  v_fmac_f32 v172, v176, v176
  v_fmac_f32 v173, v177, v177
  v_mfma_f32_16x16x32_bf16 v[164:167], v[160:163], v[144:147], v[164:167]
  v_mfma_f32_32x32x16_bf16 v[96:111], v[156:159], v[144:147], v[96:111]
  buffer_load_dwordx4 v9, s[8:11], s45 offen offset:1024 lds
  ds_read_b64_tr_b16 v[62:63], v25 offset:5120
  ds_read_b128 v[52:55], v21 offset:0
  v_lshlrev_b32 v174, 16, v146
  v_and_b32 v175, 0xffff0000, v146
  v_fmac_f32 v172, v174, v174
  v_fmac_f32 v173, v175, v175
  v_mfma_f32_32x32x16_bf16 v[112:127], v[156:159], v[148:151], v[112:127]
  v_lshlrev_b32 v176, 16, v147
  v_and_b32 v177, 0xffff0000, v147
  v_fmac_f32 v172, v176, v176
  v_fmac_f32 v173, v177, v177
  v_mfma_f32_16x16x32_bf16 v[168:171], v[160:163], v[152:155], v[168:171]
  s_waitcnt vmcnt(10) lgkmcnt(0)
  s_barrier
  v_mfma_f32_32x32x16_bf16 v[64:79], v[40:43], v[32:35], v[64:79]
  s_mul_i32 s46, s44, 221184
  s_add_u32 m0, s42, 0
  s_nop 0
  buffer_load_dwordx4 v12, s[16:19], s46 offen lds
  ds_read_b64_tr_b16 v[136:137], v24 offset:8192
  ds_read_b64_tr_b16 v[138:139], v24 offset:9216
  v_lshlrev_b32 v174, 16, v32
  v_and_b32 v175, 0xffff0000, v32
  v_fmac_f32 v172, v174, v174
  v_fmac_f32 v173, v175, v175
  v_mfma_f32_32x32x16_bf16 v[80:95], v[40:43], v[36:39], v[80:95]
  ds_read_b128 v[128:131], v18 offset:0
  v_lshlrev_b32 v176, 16, v33
  v_and_b32 v177, 0xffff0000, v33
  v_fmac_f32 v172, v176, v176
  v_fmac_f32 v173, v177, v177
  v_mfma_f32_16x16x32_bf16 v[164:167], v[160:163], v[32:35], v[164:167]
  v_mfma_f32_32x32x16_bf16 v[96:111], v[44:47], v[32:35], v[96:111]
  buffer_load_dwordx4 v13, s[16:19], s46 offen offset:1024 lds
  ds_read_b64_tr_b16 v[140:141], v25 offset:8192
  ds_read_b64_tr_b16 v[142:143], v25 offset:9216
  v_lshlrev_b32 v174, 16, v34
  v_and_b32 v175, 0xffff0000, v34
  v_fmac_f32 v172, v174, v174
  v_fmac_f32 v173, v175, v175
  v_mfma_f32_32x32x16_bf16 v[112:127], v[44:47], v[36:39], v[112:127]
  ds_read_b128 v[132:135], v22 offset:0
  v_lshlrev_b32 v176, 16, v35
  v_and_b32 v177, 0xffff0000, v35
  v_fmac_f32 v172, v176, v176
  v_fmac_f32 v173, v177, v177
  v_mfma_f32_16x16x32_bf16 v[168:171], v[160:163], v[40:43], v[168:171]
  v_mfma_f32_32x32x16_bf16 v[64:79], v[56:59], v[48:51], v[64:79]
  s_add_u32 m0, s41, 32768
  s_nop 0
  buffer_load_dwordx4 v10, s[8:11], s45 offen offset:2048 lds
  ds_read_b64_tr_b16 v[152:153], v24 offset:12288
  ds_read_b64_tr_b16 v[154:155], v24 offset:13312
  v_lshlrev_b32 v174, 16, v48
  v_and_b32 v175, 0xffff0000, v48
  v_fmac_f32 v172, v174, v174
  v_fmac_f32 v173, v175, v175
  v_mfma_f32_32x32x16_bf16 v[80:95], v[56:59], v[52:55], v[80:95]
  ds_read_b128 v[144:147], v19 offset:0
  ds_read_b64_tr_b16 v[156:157], v25 offset:12288
  v_lshlrev_b32 v176, 16, v49
  v_and_b32 v177, 0xffff0000, v49
  v_fmac_f32 v172, v176, v176
  v_fmac_f32 v173, v177, v177
  v_mfma_f32_16x16x32_bf16 v[164:167], v[160:163], v[48:51], v[164:167]
  v_mfma_f32_32x32x16_bf16 v[96:111], v[60:63], v[48:51], v[96:111]
  buffer_load_dwordx4 v11, s[8:11], s45 offen offset:3072 lds
  ds_read_b64_tr_b16 v[158:159], v25 offset:13312
  ds_read_b128 v[148:151], v23 offset:0
  v_lshlrev_b32 v174, 16, v50
  v_and_b32 v175, 0xffff0000, v50
  v_fmac_f32 v172, v174, v174
  v_fmac_f32 v173, v175, v175
  v_mfma_f32_32x32x16_bf16 v[112:127], v[60:63], v[52:55], v[112:127]
  v_lshlrev_b32 v176, 16, v51
  v_and_b32 v177, 0xffff0000, v51
  v_fmac_f32 v172, v176, v176
  v_fmac_f32 v173, v177, v177
  v_mfma_f32_16x16x32_bf16 v[168:171], v[160:163], v[56:59], v[168:171]
  s_waitcnt vmcnt(8) lgkmcnt(0)
  s_barrier
  v_mfma_f32_32x32x16_bf16 v[64:79], v[136:139], v[128:131], v[64:79]
  s_mul_i32 s46, s44, 221184
  s_add_u32 s46, s46, 110592
  s_add_u32 s44, s44, 1
  s_cmp_eq_u32 s44, 10
  s_cselect_b32 s44, 0, s44
  s_add_u32 m0, s42, 8192
  s_nop 0
  buffer_load_dwordx4 v12, s[16:19], s46 offen lds
  ds_read_b64_tr_b16 v[40:41], v24 offset:16384
  ds_read_b64_tr_b16 v[42:43], v24 offset:17408
  v_lshlrev_b32 v174, 16, v128
  v_and_b32 v175, 0xffff0000, v128
  v_fmac_f32 v172, v174, v174
  v_fmac_f32 v173, v175, v175
  v_mfma_f32_32x32x16_bf16 v[80:95], v[136:139], v[132:135], v[80:95]
  ds_read_b128 v[32:35], v16 offset:16384
  v_lshlrev_b32 v176, 16, v129
  v_and_b32 v177, 0xffff0000, v129
  v_fmac_f32 v172, v176, v176
  v_fmac_f32 v173, v177, v177
  v_mfma_f32_16x16x32_bf16 v[164:167], v[160:163], v[128:131], v[164:167]
  v_mfma_f32_32x32x16_bf16 v[96:111], v[140:143], v[128:131], v[96:111]
  buffer_load_dwordx4 v13, s[16:19], s46 offen offset:1024 lds
  ds_read_b64_tr_b16 v[44:45], v25 offset:16384
  ds_read_b64_tr_b16 v[46:47], v25 offset:17408
  v_lshlrev_b32 v174, 16, v130
  v_and_b32 v175, 0xffff0000, v130
  v_fmac_f32 v172, v174, v174
  v_fmac_f32 v173, v175, v175
  v_mfma_f32_32x32x16_bf16 v[112:127], v[140:143], v[132:135], v[112:127]
  ds_read_b128 v[36:39], v20 offset:16384
  v_lshlrev_b32 v176, 16, v131
  v_and_b32 v177, 0xffff0000, v131
  v_fmac_f32 v172, v176, v176
  v_fmac_f32 v173, v177, v177
  v_mfma_f32_16x16x32_bf16 v[168:171], v[160:163], v[136:139], v[168:171]
  v_mfma_f32_32x32x16_bf16 v[64:79], v[152:155], v[144:147], v[64:79]
  s_lshl_b32 s45, s43, 7
  s_add_u32 s43, s43, 1
  s_cmp_eq_u32 s43, 10
  s_cselect_b32 s43, 0, s43
  s_add_u32 m0, s41, 0
  s_nop 0
  buffer_load_dwordx4 v8, s[8:11], s45 offen offset:0 lds
  ds_read_b64_tr_b16 v[56:57], v24 offset:20480
  ds_read_b64_tr_b16 v[58:59], v24 offset:21504
  v_lshlrev_b32 v174, 16, v144
  v_and_b32 v175, 0xffff0000, v144
  v_fmac_f32 v172, v174, v174
  v_fmac_f32 v173, v175, v175
  v_mfma_f32_32x32x16_bf16 v[80:95], v[152:155], v[148:151], v[80:95]
  ds_read_b128 v[48:51], v17 offset:16384
  ds_read_b64_tr_b16 v[60:61], v25 offset:20480
  v_lshlrev_b32 v176, 16, v145
  v_and_b32 v177, 0xffff0000, v145
  v_fmac_f32 v172, v176, v176
  v_fmac_f32 v173, v177, v177
  v_mfma_f32_16x16x32_bf16 v[164:167], v[160:163], v[144:147], v[164:167]
  v_mfma_f32_32x32x16_bf16 v[96:111], v[156:159], v[144:147], v[96:111]
  buffer_load_dwordx4 v9, s[8:11], s45 offen offset:1024 lds
  ds_read_b64_tr_b16 v[62:63], v25 offset:21504
  ds_read_b128 v[52:55], v21 offset:16384
  v_lshlrev_b32 v174, 16, v146
  v_and_b32 v175, 0xffff0000, v146
  v_fmac_f32 v172, v174, v174
  v_fmac_f32 v173, v175, v175
  v_mfma_f32_32x32x16_bf16 v[112:127], v[156:159], v[148:151], v[112:127]
  v_lshlrev_b32 v176, 16, v147
  v_and_b32 v177, 0xffff0000, v147
  v_fmac_f32 v172, v176, v176
  v_fmac_f32 v173, v177, v177
  v_mfma_f32_16x16x32_bf16 v[168:171], v[160:163], v[152:155], v[168:171]
  s_waitcnt vmcnt(10) lgkmcnt(0)
  s_barrier
  v_mfma_f32_32x32x16_bf16 v[64:79], v[40:43], v[32:35], v[64:79]
  s_mul_i32 s46, s44, 221184
  s_add_u32 m0, s42, 16384
  s_nop 0
  buffer_load_dwordx4 v12, s[16:19], s46 offen lds
  ds_read_b64_tr_b16 v[136:137], v24 offset:24576
  ds_read_b64_tr_b16 v[138:139], v24 offset:25600
  v_lshlrev_b32 v174, 16, v32
  v_and_b32 v175, 0xffff0000, v32
  v_fmac_f32 v172, v174, v174
  v_fmac_f32 v173, v175, v175
  v_mfma_f32_32x32x16_bf16 v[80:95], v[40:43], v[36:39], v[80:95]
  ds_read_b128 v[128:131], v18 offset:16384
  v_lshlrev_b32 v176, 16, v33
  v_and_b32 v177, 0xffff0000, v33
  v_fmac_f32 v172, v176, v176
  v_fmac_f32 v173, v177, v177
  v_mfma_f32_16x16x32_bf16 v[164:167], v[160:163], v[32:35], v[164:167]
  v_mfma_f32_32x32x16_bf16 v[96:111], v[44:47], v[32:35], v[96:111]
  buffer_load_dwordx4 v13, s[16:19], s46 offen offset:1024 lds
  ds_read_b64_tr_b16 v[140:141], v25 offset:24576
  ds_read_b64_tr_b16 v[142:143], v25 offset:25600
  v_lshlrev_b32 v174, 16, v34
  v_and_b32 v175, 0xffff0000, v34
  v_fmac_f32 v172, v174, v174
  v_fmac_f32 v173, v175, v175
  v_mfma_f32_32x32x16_bf16 v[112:127], v[44:47], v[36:39], v[112:127]
  ds_read_b128 v[132:135], v22 offset:16384
  v_lshlrev_b32 v176, 16, v35
  v_and_b32 v177, 0xffff0000, v35
  v_fmac_f32 v172, v176, v176
  v_fmac_f32 v173, v177, v177
  v_mfma_f32_16x16x32_bf16 v[168:171], v[160:163], v[40:43], v[168:171]
  v_mfma_f32_32x32x16_bf16 v[64:79], v[56:59], v[48:51], v[64:79]
  s_add_u32 m0, s41, 0
  s_nop 0
  buffer_load_dwordx4 v10, s[8:11], s45 offen offset:2048 lds
  ds_read_b64_tr_b16 v[152:153], v24 offset:28672
  ds_read_b64_tr_b16 v[154:155], v24 offset:29696
  v_lshlrev_b32 v174, 16, v48
  v_and_b32 v175, 0xffff0000, v48
  v_fmac_f32 v172, v174, v174
  v_fmac_f32 v173, v175, v175
  v_mfma_f32_32x32x16_bf16 v[80:95], v[56:59], v[52:55], v[80:95]
  ds_read_b128 v[144:147], v19 offset:16384
  ds_read_b64_tr_b16 v[156:157], v25 offset:28672
  v_lshlrev_b32 v176, 16, v49
  v_and_b32 v177, 0xffff0000, v49
  v_fmac_f32 v172, v176, v176
  v_fmac_f32 v173, v177, v177
  v_mfma_f32_16x16x32_bf16 v[164:167], v[160:163], v[48:51], v[164:167]
  v_mfma_f32_32x32x16_bf16 v[96:111], v[60:63], v[48:51], v[96:111]
  buffer_load_dwordx4 v11, s[8:11], s45 offen offset:3072 lds
  ds_read_b64_tr_b16 v[158:159], v25 offset:29696
  ds_read_b128 v[148:151], v23 offset:16384
  v_lshlrev_b32 v174, 16, v50
  v_and_b32 v175, 0xffff0000, v50
  v_fmac_f32 v172, v174, v174
  v_fmac_f32 v173, v175, v175
  v_mfma_f32_32x32x16_bf16 v[112:127], v[60:63], v[52:55], v[112:127]
  v_lshlrev_b32 v176, 16, v51
  v_and_b32 v177, 0xffff0000, v51
  v_fmac_f32 v172, v176, v176
  v_fmac_f32 v173, v177, v177
  v_mfma_f32_16x16x32_bf16 v[168:171], v[160:163], v[56:59], v[168:171]
  s_waitcnt vmcnt(8) lgkmcnt(0)
  s_barrier
  v_mfma_f32_32x32x16_bf16 v[64:79], v[136:139], v[128:131], v[64:79]
  s_mul_i32 s46, s44, 221184
  s_add_u32 s46, s46, 110592
  s_add_u32 s44, s44, 1
  s_cmp_eq_u32 s44, 10
  s_cselect_b32 s44, 0, s44
  s_add_u32 m0, s42, 24576
  s_nop 0
  buffer_load_dwordx4 v12, s[16:19], s46 offen lds
  ds_read_b64_tr_b16 v[40:41], v24 offset:0
  ds_read_b64_tr_b16 v[42:43], v24 offset:1024
  v_lshlrev_b32 v174, 16, v128
  v_and_b32 v175, 0xffff0000, v128
  v_fmac_f32 v172, v174, v174
  v_fmac_f32 v173, v175, v175
  v_mfma_f32_32x32x16_bf16 v[80:95], v[136:139], v[132:135], v[80:95]
  ds_read_b128 v[32:35], v16 offset:32768
  v_lshlrev_b32 v176, 16, v129
  v_and_b32 v177, 0xffff0000, v129
  v_fmac_f32 v172, v176, v176
  v_fmac_f32 v173, v177, v177
  v_mfma_f32_16x16x32_bf16 v[164:167], v[160:163], v[128:131], v[164:167]
  v_mfma_f32_32x32x16_bf16 v[96:111], v[140:143], v[128:131], v[96:111]
  buffer_load_dwordx4 v13, s[16:19], s46 offen offset:1024 lds
  ds_read_b64_tr_b16 v[44:45], v25 offset:0
  ds_read_b64_tr_b16 v[46:47], v25 offset:1024
  v_lshlrev_b32 v174, 16, v130
  v_and_b32 v175, 0xffff0000, v130
  v_fmac_f32 v172, v174, v174
  v_fmac_f32 v173, v175, v175
  v_mfma_f32_32x32x16_bf16 v[112:127], v[140:143], v[132:135], v[112:127]
  ds_read_b128 v[36:39], v20 offset:32768
  v_lshlrev_b32 v176, 16, v131
  v_and_b32 v177, 0xffff0000, v131
  v_fmac_f32 v172, v176, v176
  v_fmac_f32 v173, v177, v177
  v_mfma_f32_16x16x32_bf16 v[168:171], v[160:163], v[136:139], v[168:171]
  v_mfma_f32_32x32x16_bf16 v[64:79], v[152:155], v[144:147], v[64:79]
  ds_read_b64_tr_b16 v[56:57], v24 offset:4096
  ds_read_b64_tr_b16 v[58:59], v24 offset:5120
  v_lshlrev_b32 v174, 16, v144
  v_and_b32 v175, 0xffff0000, v144
  v_fmac_f32 v172, v174, v174
  v_fmac_f32 v173, v175, v175
  v_mfma_f32_32x32x16_bf16 v[80:95], v[152:155], v[148:151], v[80:95]
  ds_read_b128 v[48:51], v17 offset:32768
  ds_read_b64_tr_b16 v[60:61], v25 offset:4096
  v_lshlrev_b32 v176, 16, v145
  v_and_b32 v177, 0xffff0000, v145
  v_fmac_f32 v172, v176, v176
  v_fmac_f32 v173, v177, v177
  v_mfma_f32_16x16x32_bf16 v[164:167], v[160:163], v[144:147], v[164:167]
  v_mfma_f32_32x32x16_bf16 v[96:111], v[156:159], v[144:147], v[96:111]
  ds_read_b64_tr_b16 v[62:63], v25 offset:5120
  ds_read_b128 v[52:55], v21 offset:32768
  v_lshlrev_b32 v174, 16, v146
  v_and_b32 v175, 0xffff0000, v146
  v_fmac_f32 v172, v174, v174
  v_fmac_f32 v173, v175, v175
  v_mfma_f32_32x32x16_bf16 v[112:127], v[156:159], v[148:151], v[112:127]
  v_lshlrev_b32 v176, 16, v147
  v_and_b32 v177, 0xffff0000, v147
  v_fmac_f32 v172, v176, v176
  v_fmac_f32 v173, v177, v177
  v_mfma_f32_16x16x32_bf16 v[168:171], v[160:163], v[152:155], v[168:171]
  s_waitcnt vmcnt(8) lgkmcnt(0)
  s_barrier
  v_mfma_f32_32x32x16_bf16 v[64:79], v[40:43], v[32:35], v[64:79]
  s_add_u32 m0, s62, 0
  s_nop 0
  buffer_load_dwordx4 v28, s[24:27], s54 offen lds
  ds_read_b64_tr_b16 v[136:137], v24 offset:8192
  ds_read_b64_tr_b16 v[138:139], v24 offset:9216
  v_lshlrev_b32 v174, 16, v32
  v_and_b32 v175, 0xffff0000, v32
  v_fmac_f32 v172, v174, v174
  v_fmac_f32 v173, v175, v175
  v_mfma_f32_32x32x16_bf16 v[80:95], v[40:43], v[36:39], v[80:95]
  ds_read_b128 v[128:131], v18 offset:32768
  v_lshlrev_b32 v176, 16, v33
  v_and_b32 v177, 0xffff0000, v33
  v_fmac_f32 v172, v176, v176
  v_fmac_f32 v173, v177, v177
  v_mfma_f32_16x16x32_bf16 v[164:167], v[160:163], v[32:35], v[164:167]
  v_mfma_f32_32x32x16_bf16 v[96:111], v[44:47], v[32:35], v[96:111]
  s_add_u32 m0, s62, 1024
  s_nop 0
  buffer_load_dwordx4 v28, s[24:27], s55 offen lds
  ds_read_b64_tr_b16 v[140:141], v25 offset:8192
  ds_read_b64_tr_b16 v[142:143], v25 offset:9216
  v_lshlrev_b32 v174, 16, v34
  v_and_b32 v175, 0xffff0000, v34
  v_fmac_f32 v172, v174, v174
  v_fmac_f32 v173, v175, v175
  v_mfma_f32_32x32x16_bf16 v[112:127], v[44:47], v[36:39], v[112:127]
  ds_read_b128 v[132:135], v22 offset:32768
  v_lshlrev_b32 v176, 16, v35
  v_and_b32 v177, 0xffff0000, v35
  v_fmac_f32 v172, v176, v176
  v_fmac_f32 v173, v177, v177
  v_mfma_f32_16x16x32_bf16 v[168:171], v[160:163], v[40:43], v[168:171]
  v_mfma_f32_32x32x16_bf16 v[64:79], v[56:59], v[48:51], v[64:79]
  s_add_u32 m0, s62, 2048
  s_nop 0
  buffer_load_dwordx4 v28, s[24:27], s56 offen lds
  ds_read_b64_tr_b16 v[152:153], v24 offset:12288
  ds_read_b64_tr_b16 v[154:155], v24 offset:13312
  v_lshlrev_b32 v174, 16, v48
  v_and_b32 v175, 0xffff0000, v48
  v_fmac_f32 v172, v174, v174
  v_fmac_f32 v173, v175, v175
  v_mfma_f32_32x32x16_bf16 v[80:95], v[56:59], v[52:55], v[80:95]
  ds_read_b128 v[144:147], v19 offset:32768
  ds_read_b64_tr_b16 v[156:157], v25 offset:12288
  v_lshlrev_b32 v176, 16, v49
  v_and_b32 v177, 0xffff0000, v49
  v_fmac_f32 v172, v176, v176
  v_fmac_f32 v173, v177, v177
  v_mfma_f32_16x16x32_bf16 v[164:167], v[160:163], v[48:51], v[164:167]
  v_mfma_f32_32x32x16_bf16 v[96:111], v[60:63], v[48:51], v[96:111]
  ds_read_b64_tr_b16 v[158:159], v25 offset:13312
  ds_read_b128 v[148:151], v23 offset:32768
  v_lshlrev_b32 v174, 16, v50
  v_and_b32 v175, 0xffff0000, v50
  v_fmac_f32 v172, v174, v174
  v_fmac_f32 v173, v175, v175
  v_mfma_f32_32x32x16_bf16 v[112:127], v[60:63], v[52:55], v[112:127]
  v_lshlrev_b32 v176, 16, v51
  v_and_b32 v177, 0xffff0000, v51
  v_fmac_f32 v172, v176, v176
  v_fmac_f32 v173, v177, v177
  v_mfma_f32_16x16x32_bf16 v[168:171], v[160:163], v[56:59], v[168:171]
  s_waitcnt vmcnt(5) lgkmcnt(0)
  s_barrier
  v_mfma_f32_32x32x16_bf16 v[64:79], v[136:139], v[128:131], v[64:79]
  ds_read_b64_tr_b16 v[40:41], v24 offset:16384
  ds_read_b64_tr_b16 v[42:43], v24 offset:17408
  v_lshlrev_b32 v174, 16, v128
  v_and_b32 v175, 0xffff0000, v128
  v_fmac_f32 v172, v174, v174
  v_fmac_f32 v173, v175, v175
  v_mfma_f32_32x32x16_bf16 v[80:95], v[136:139], v[132:135], v[80:95]
  ds_read_b128 v[32:35], v16 offset:0
  v_lshlrev_b32 v176, 16, v129
  v_and_b32 v177, 0xffff0000, v129
  v_fmac_f32 v172, v176, v176
  v_fmac_f32 v173, v177, v177
  v_mfma_f32_16x16x32_bf16 v[164:167], v[160:163], v[128:131], v[164:167]
  v_mfma_f32_32x32x16_bf16 v[96:111], v[140:143], v[128:131], v[96:111]
  ds_read_b64_tr_b16 v[44:45], v25 offset:16384
  ds_read_b64_tr_b16 v[46:47], v25 offset:17408
  v_lshlrev_b32 v174, 16, v130
  v_and_b32 v175, 0xffff0000, v130
  v_fmac_f32 v172, v174, v174
  v_fmac_f32 v173, v175, v175
  v_mfma_f32_32x32x16_bf16 v[112:127], v[140:143], v[132:135], v[112:127]
  ds_read_b128 v[36:39], v20 offset:0
  v_lshlrev_b32 v176, 16, v131
  v_and_b32 v177, 0xffff0000, v131
  v_fmac_f32 v172, v176, v176
  v_fmac_f32 v173, v177, v177
  v_mfma_f32_16x16x32_bf16 v[168:171], v[160:163], v[136:139], v[168:171]
  v_mfma_f32_32x32x16_bf16 v[64:79], v[152:155], v[144:147], v[64:79]
  ds_read_b64_tr_b16 v[56:57], v24 offset:20480
  ds_read_b64_tr_b16 v[58:59], v24 offset:21504
  v_lshlrev_b32 v174, 16, v144
  v_and_b32 v175, 0xffff0000, v144
  v_fmac_f32 v172, v174, v174
  v_fmac_f32 v173, v175, v175
  v_mfma_f32_32x32x16_bf16 v[80:95], v[152:155], v[148:151], v[80:95]
  ds_read_b128 v[48:51], v17 offset:0
  ds_read_b64_tr_b16 v[60:61], v25 offset:20480
  v_lshlrev_b32 v176, 16, v145
  v_and_b32 v177, 0xffff0000, v145
  v_fmac_f32 v172, v176, v176
  v_fmac_f32 v173, v177, v177
  v_mfma_f32_16x16x32_bf16 v[164:167], v[160:163], v[144:147], v[164:167]
  v_mfma_f32_32x32x16_bf16 v[96:111], v[156:159], v[144:147], v[96:111]
  ds_read_b64_tr_b16 v[62:63], v25 offset:21504
  ds_read_b128 v[52:55], v21 offset:0
  v_lshlrev_b32 v174, 16, v146
  v_and_b32 v175, 0xffff0000, v146
  v_fmac_f32 v172, v174, v174
  v_fmac_f32 v173, v175, v175
  v_mfma_f32_32x32x16_bf16 v[112:127], v[156:159], v[148:151], v[112:127]
  v_lshlrev_b32 v176, 16, v147
  v_and_b32 v177, 0xffff0000, v147
  v_fmac_f32 v172, v176, v176
  v_fmac_f32 v173, v177, v177
  v_mfma_f32_16x16x32_bf16 v[168:171], v[160:163], v[152:155], v[168:171]
  s_waitcnt vmcnt(3) lgkmcnt(0)
  s_barrier
  v_mfma_f32_32x32x16_bf16 v[64:79], v[40:43], v[32:35], v[64:79]
  ds_read_b64_tr_b16 v[136:137], v24 offset:24576
  ds_read_b64_tr_b16 v[138:139], v24 offset:25600
  v_lshlrev_b32 v174, 16, v32
  v_and_b32 v175, 0xffff0000, v32
  v_fmac_f32 v172, v174, v174
  v_fmac_f32 v173, v175, v175
  v_mfma_f32_32x32x16_bf16 v[80:95], v[40:43], v[36:39], v[80:95]
  ds_read_b128 v[128:131], v18 offset:0
  v_lshlrev_b32 v176, 16, v33
  v_and_b32 v177, 0xffff0000, v33
  v_fmac_f32 v172, v176, v176
  v_fmac_f32 v173, v177, v177
  v_mfma_f32_16x16x32_bf16 v[164:167], v[160:163], v[32:35], v[164:167]
  v_mfma_f32_32x32x16_bf16 v[96:111], v[44:47], v[32:35], v[96:111]
  ds_read_b64_tr_b16 v[140:141], v25 offset:24576
  ds_read_b64_tr_b16 v[142:143], v25 offset:25600
  v_lshlrev_b32 v174, 16, v34
  v_and_b32 v175, 0xffff0000, v34
  v_fmac_f32 v172, v174, v174
  v_fmac_f32 v173, v175, v175
  v_mfma_f32_32x32x16_bf16 v[112:127], v[44:47], v[36:39], v[112:127]
  ds_read_b128 v[132:135], v22 offset:0
  v_lshlrev_b32 v176, 16, v35
  v_and_b32 v177, 0xffff0000, v35
  v_fmac_f32 v172, v176, v176
  v_fmac_f32 v173, v177, v177
  v_mfma_f32_16x16x32_bf16 v[168:171], v[160:163], v[40:43], v[168:171]
  v_mfma_f32_32x32x16_bf16 v[64:79], v[56:59], v[48:51], v[64:79]
  ds_read_b64_tr_b16 v[152:153], v24 offset:28672
  ds_read_b64_tr_b16 v[154:155], v24 offset:29696
  v_lshlrev_b32 v174, 16, v48
  v_and_b32 v175, 0xffff0000, v48
  v_fmac_f32 v172, v174, v174
  v_fmac_f32 v173, v175, v175
  v_mfma_f32_32x32x16_bf16 v[80:95], v[56:59], v[52:55], v[80:95]
  ds_read_b128 v[144:147], v19 offset:0
  ds_read_b64_tr_b16 v[156:157], v25 offset:28672
  v_lshlrev_b32 v176, 16, v49
  v_and_b32 v177, 0xffff0000, v49
  v_fmac_f32 v172, v176, v176
  v_fmac_f32 v173, v177, v177
  v_mfma_f32_16x16x32_bf16 v[164:167], v[160:163], v[48:51], v[164:167]
  v_mfma_f32_32x32x16_bf16 v[96:111], v[60:63], v[48:51], v[96:111]
  ds_read_b64_tr_b16 v[158:159], v25 offset:29696
  ds_read_b128 v[148:151], v23 offset:0
  v_lshlrev_b32 v174, 16, v50
  v_and_b32 v175, 0xffff0000, v50
  v_fmac_f32 v172, v174, v174
  v_fmac_f32 v173, v175, v175
  v_mfma_f32_32x32x16_bf16 v[112:127], v[60:63], v[52:55], v[112:127]
  v_lshlrev_b32 v176, 16, v51
  v_and_b32 v177, 0xffff0000, v51
  v_fmac_f32 v172, v176, v176
  v_fmac_f32 v173, v177, v177
  v_mfma_f32_16x16x32_bf16 v[168:171], v[160:163], v[56:59], v[168:171]
  s_waitcnt lgkmcnt(0)
  s_barrier
  v_mfma_f32_16x16x32_bf16 v[164:167], v[160:163], v[128:131], v[164:167]
  v_mfma_f32_16x16x32_bf16 v[168:171], v[160:163], v[136:139], v[168:171]
  v_mfma_f32_16x16x32_bf16 v[164:167], v[160:163], v[144:147], v[164:167]
  v_mfma_f32_16x16x32_bf16 v[168:171], v[160:163], v[152:155], v[168:171]
  v_mfma_f32_32x32x16_bf16 v[64:79], v[136:139], v[128:131], v[64:79]
  v_lshlrev_b32 v174, 16, v128
  v_and_b32 v175, 0xffff0000, v128
  v_fmac_f32 v172, v174, v174
  v_fmac_f32 v173, v175, v175
  v_lshlrev_b32 v176, 16, v129
  v_and_b32 v177, 0xffff0000, v129
  v_fmac_f32 v172, v176, v176
  v_fmac_f32 v173, v177, v177
  v_lshlrev_b32 v174, 16, v130
  v_and_b32 v175, 0xffff0000, v130
  v_fmac_f32 v172, v174, v174
  v_fmac_f32 v173, v175, v175
  v_lshlrev_b32 v176, 16, v131
  v_and_b32 v177, 0xffff0000, v131
  v_fmac_f32 v172, v176, v176
  v_fmac_f32 v173, v177, v177
  v_mfma_f32_32x32x16_bf16 v[80:95], v[136:139], v[132:135], v[80:95]
  v_lshlrev_b32 v174, 16, v144
  v_and_b32 v175, 0xffff0000, v144
  v_fmac_f32 v172, v174, v174
  v_fmac_f32 v173, v175, v175
  v_lshlrev_b32 v176, 16, v145
  v_and_b32 v177, 0xffff0000, v145
  v_fmac_f32 v172, v176, v176
  v_fmac_f32 v173, v177, v177
  v_lshlrev_b32 v174, 16, v146
  v_and_b32 v175, 0xffff0000, v146
  v_fmac_f32 v172, v174, v174
  v_fmac_f32 v173, v175, v175
  v_lshlrev_b32 v176, 16, v147
  v_and_b32 v177, 0xffff0000, v147
  v_fmac_f32 v172, v176, v176
  v_fmac_f32 v173, v177, v177
  v_mfma_f32_32x32x16_bf16 v[96:111], v[140:143], v[128:131], v[96:111]
  v_and_b32 v5, 16, v1
  v_cmp_ne_u32 vcc, 0, v5
  v_add_f32 v6, v172, v173
  v_mov_b32 v8, v6
  v_cndmask_b32 v5, v164, v165, vcc
  v_cndmask_b32 v7, v168, v169, vcc
  v_permlane32_swap_b32 v6, v8
  v_mul_f32 v5, 0x3acccccd, v5
  v_add_f32 v6, v6, v8
  v_mul_f32 v6, 0x3acccccd, v6
  v_fma_f32 v6, -v5, v5, v6
  v_max_f32 v6, 0, v6
  v_mfma_f32_32x32x16_bf16 v[112:127], v[140:143], v[132:135], v[112:127]
  v_cvt_pk_bf16_f32 v8, v6, v6
  v_and_b32 v8, 0xffff0000, v8
  v_cvt_pk_bf16_f32 v9, v5, v5
  v_and_b32 v9, 0xffff0000, v9
  v_add_f32 v8, 0x3727c5ac, v8
  v_cvt_pk_bf16_f32 v8, v8, v8
  v_and_b32 v8, 0xffff0000, v8
  v_sqrt_f32 v8, v8
  s_nop 0
  v_cvt_pk_bf16_f32 v8, v8, v8
  v_and_b32 v8, 0xffff0000, v8
  v_rcp_f32 v10, v8
  v_sub_f32 v5, v5, v9
  v_cvt_pk_bf16_f32 v188, v7, v7
  v_mul_f32 v6, v6, v10
  v_mul_f32 v5, v5, v10
  v_mul_f32 v6, v6, v10
  v_and_b32 v11, 0xffff0000, v188
  v_sub_f32 v11, v7, v11
  v_mfma_f32_32x32x16_bf16 v[64:79], v[152:155], v[144:147], v[64:79]
  v_cvt_pk_bf16_f32 v6, v6, v6
  v_and_b32 v6, 0xffff0000, v6
  v_cvt_pk_bf16_f32 v5, v5, v5
  v_and_b32 v5, 0xffff0000, v5
  v_add_f32 v6, 0x3727c5ac, v6
  v_cvt_pk_bf16_f32 v6, v6, v6
  v_and_b32 v6, 0xffff0000, v6
  v_sqrt_f32 v6, v6
  v_cvt_pk_bf16_f32 v11, v11, 0
  v_cmp_gt_u32 vcc, 32, v1
  v_lshlrev_b32 v12, 2, v1
  s_lshl_b32 s50, s37, 10
  s_add_u32 s50, s50, 16384
  v_add_u32 v12, s50, v12
  v_cndmask_b32 v188, 0, v188, vcc
  v_cndmask_b32 v11, 0, v11, vcc
  v_cvt_pk_bf16_f32 v6, v6, v6
  v_and_b32 v6, 0xffff0000, v6
  ds_write_b32 v12, v188 offset:0
  ds_write_b32 v12, v11 offset:256
  v_mul_f32 v200, v8, v6
  v_fma_f32 v5, v5, v8, v9
  v_rcp_f32 v10, v200
  v_sub_f32 v5, 0, v5
  v_mfma_f32_32x32x16_bf16 v[80:95], v[152:155], v[148:151], v[80:95]
  v_cvt_pk_bf16_f32 v181, v5, v200
  v_lshlrev_b32 v9, 16, v181
  v_and_b32 v8, 0xffff0000, v181
  v_sub_f32 v9, v5, v9
  v_sub_f32 v8, v200, v8
  v_cvt_pk_bf16_f32 v180, v5, v9
  v_cvt_pk_bf16_f32 v182, v8, 0
  v_mul_f32 v197, 0xc0135761, v10
  v_mul_f32 v196, v10, v10
  v_mov_b32 v183, 0
  v_mul_f32 v196, v196, v197
  v_mov_b32 v187, 0
  v_mul_f32 v196, 0x3d372713, v196
  v_lshlrev_b32 v13, 4, v2
  s_lshl_b32 s50, s37, 10
  s_add_u32 s50, s50, 20480
  v_add_u32 v13, s50, v13
  v_mov_b32 v8, v180
  v_mov_b32 v9, v181
  v_mov_b32 v10, v182
  v_mov_b32 v14, v200
  v_mov_b32 v15, v11
  v_mov_b32 v11, v14
  ds_write_b128 v13, v[8:11]
  ds_write_b64 v13, v[196:197] offset:512
  v_mfma_f32_32x32x16_bf16 v[96:111], v[156:159], v[144:147], v[96:111]
  v_lshl_or_b32 v189, v26, 16, v15
  v_cndmask_b32 v189, 0, v189, vcc
  v_cndmask_b32 v190, 0, v26, vcc
  v_mov_b32 v191, 0
  v_mov_b32 v195, 0
  v_cndmask_b32 v194, 0, v27, vcc
  v_xor_b32 v12, 0x400, v12
  v_xor_b32 v13, 0x800, v13
  s_waitcnt lgkmcnt(0)
  s_barrier
  ds_read_b32 v192, v12 offset:0
  ds_read_b32 v15, v12 offset:256
  ds_read_b128 v[8:11], v13
  ds_read_b64 v[198:199], v13 offset:512
  v_mfma_f32_32x32x16_bf16 v[112:127], v[156:159], v[148:151], v[112:127]
  v_mfma_f32_32x32x16_bf16 v[64:79], v[188:191], v[180:183], v[64:79]
  s_waitcnt lgkmcnt(0)
  v_lshl_or_b32 v193, v27, 16, v15
  v_mov_b32 v184, v8
  v_mov_b32 v185, v9
  v_mov_b32 v186, v10
  v_mov_b32 v202, v11
  v_cndmask_b32 v193, 0, v193, vcc
  v_mfma_f32_32x32x16_bf16 v[80:95], v[188:191], v[184:187], v[80:95]
  s_nop 0
  v_mfma_f32_32x32x16_bf16 v[96:111], v[192:195], v[180:183], v[96:111]
  v_mfma_f32_32x32x16_bf16 v[112:127], v[192:195], v[184:187], v[112:127]
  s_cmp_eq_u32 s34, 13
  s_cselect_b32 s50, s48, 0
  s_cmp_lg_u32 s50, 0
  s_cbranch_scc1 G1_done
  v_bfe_u32 v6, v1, 4, 1
  v_lshlrev_b32 v6, 10, v6
  v_lshl_add_u32 v6, v3, 9, v6
  v_and_b32 v7, 15, v1
  v_lshl_add_u32 v6, v7, 4, v6
  s_lshl_b32 s50, s33, 1
  s_add_u32 s50, s50, s47
  s_mul_i32 s50, s50, 54
  s_lshl_b32 s51, s34, 2
  s_add_u32 s50, s50, s51
  s_lshl_b32 s51, s48, 1
  s_add_u32 s50, s50, s51
  s_add_u32 s50, s50, s47
  s_lshl_b32 s50, s50, 12
  s_lshl_b32 s51, s48, 11
  s_add_u32 s50, s50, s51
  s_xor_b32 s51, s50, 0x800
  s_xor_b32 s52, s50, 0x1000
  s_xor_b32 s53, s50, 0x1800
  v_pk_mul_f32 v[204:205], v[64:65], v[64:65]
  v_pk_mul_f32 v[206:207], v[66:67], v[66:67]
  v_pk_mul_f32 v[208:209], v[68:69], v[68:69]
  v_pk_mul_f32 v[210:211], v[70:71], v[70:71]
  v_pk_fma_f32 v[204:205], v[204:205], v[196:197], v[196:197] op_sel:[0,0,1] op_sel_hi:[1,0,1]
  v_pk_fma_f32 v[206:207], v[206:207], v[196:197], v[196:197] op_sel:[0,0,1] op_sel_hi:[1,0,1]
  v_pk_fma_f32 v[208:209], v[208:209], v[196:197], v[196:197] op_sel:[0,0,1] op_sel_hi:[1,0,1]
  v_pk_fma_f32 v[210:211], v[210:211], v[196:197], v[196:197] op_sel:[0,0,1] op_sel_hi:[1,0,1]
  v_pk_mul_f32 v[204:205], v[204:205], v[64:65]
  v_pk_mul_f32 v[206:207], v[206:207], v[66:67]
  v_pk_mul_f32 v[208:209], v[208:209], v[68:69]
  v_pk_mul_f32 v[210:211], v[210:211], v[70:71]
  v_exp_f32 v204, v204
  v_exp_f32 v205, v205
  v_exp_f32 v206, v206
  v_exp_f32 v207, v207
  v_exp_f32 v208, v208
  v_exp_f32 v209, v209
  v_exp_f32 v210, v210
  v_exp_f32 v211, v211
  v_pk_fma_f32 v[204:205], v[204:205], v[200:201], v[200:201] op_sel_hi:[1,0,0]
  v_pk_fma_f32 v[206:207], v[206:207], v[200:201], v[200:201] op_sel_hi:[1,0,0]
  v_pk_fma_f32 v[208:209], v[208:209], v[200:201], v[200:201] op_sel_hi:[1,0,0]
  v_pk_fma_f32 v[210:211], v[210:211], v[200:201], v[200:201] op_sel_hi:[1,0,0]
  v_rcp_f32 v204, v204
  v_rcp_f32 v205, v205
  v_rcp_f32 v206, v206
  v_rcp_f32 v207, v207
  v_rcp_f32 v208, v208
  v_rcp_f32 v209, v209
  v_rcp_f32 v210, v210
  v_rcp_f32 v211, v211
  v_pk_mul_f32 v[204:205], v[204:205], v[64:65]
  v_pk_mul_f32 v[206:207], v[206:207], v[66:67]
  v_pk_mul_f32 v[208:209], v[208:209], v[68:69]
  v_pk_mul_f32 v[210:211], v[210:211], v[70:71]
  v_cvt_pk_bf16_f32 v224, v204, v205
  v_cvt_pk_bf16_f32 v225, v206, v207
  v_cvt_pk_bf16_f32 v226, v208, v209
  v_cvt_pk_bf16_f32 v227, v210, v211
  buffer_store_dwordx4 v[224:227], v6, s[12:15], s50 offen offset:0 sc1
  v_pk_mul_f32 v[204:205], v[72:73], v[72:73]
  v_pk_mul_f32 v[206:207], v[74:75], v[74:75]
  v_pk_mul_f32 v[208:209], v[76:77], v[76:77]
  v_pk_mul_f32 v[210:211], v[78:79], v[78:79]
  v_pk_fma_f32 v[204:205], v[204:205], v[196:197], v[196:197] op_sel:[0,0,1] op_sel_hi:[1,0,1]
  v_pk_fma_f32 v[206:207], v[206:207], v[196:197], v[196:197] op_sel:[0,0,1] op_sel_hi:[1,0,1]
  v_pk_fma_f32 v[208:209], v[208:209], v[196:197], v[196:197] op_sel:[0,0,1] op_sel_hi:[1,0,1]
  v_pk_fma_f32 v[210:211], v[210:211], v[196:197], v[196:197] op_sel:[0,0,1] op_sel_hi:[1,0,1]
  v_pk_mul_f32 v[204:205], v[204:205], v[72:73]
  v_pk_mul_f32 v[206:207], v[206:207], v[74:75]
  v_pk_mul_f32 v[208:209], v[208:209], v[76:77]
  v_pk_mul_f32 v[210:211], v[210:211], v[78:79]
  v_exp_f32 v204, v204
  v_exp_f32 v205, v205
  v_exp_f32 v206, v206
  v_exp_f32 v207, v207
  v_exp_f32 v208, v208
  v_exp_f32 v209, v209
  v_exp_f32 v210, v210
  v_exp_f32 v211, v211
  v_pk_fma_f32 v[204:205], v[204:205], v[200:201], v[200:201] op_sel_hi:[1,0,0]
  v_pk_fma_f32 v[206:207], v[206:207], v[200:201], v[200:201] op_sel_hi:[1,0,0]
  v_pk_fma_f32 v[208:209], v[208:209], v[200:201], v[200:201] op_sel_hi:[1,0,0]
  v_pk_fma_f32 v[210:211], v[210:211], v[200:201], v[200:201] op_sel_hi:[1,0,0]
  v_rcp_f32 v204, v204
  v_rcp_f32 v205, v205
  v_rcp_f32 v206, v206
  v_rcp_f32 v207, v207
  v_rcp_f32 v208, v208
  v_rcp_f32 v209, v209
  v_rcp_f32 v210, v210
  v_rcp_f32 v211, v211
  v_pk_mul_f32 v[204:205], v[204:205], v[72:73]
  v_pk_mul_f32 v[206:207], v[206:207], v[74:75]
  v_pk_mul_f32 v[208:209], v[208:209], v[76:77]
  v_pk_mul_f32 v[210:211], v[210:211], v[78:79]
  v_cvt_pk_bf16_f32 v228, v204, v205
  v_cvt_pk_bf16_f32 v229, v206, v207
  v_cvt_pk_bf16_f32 v230, v208, v209
  v_cvt_pk_bf16_f32 v231, v210, v211
  buffer_store_dwordx4 v[228:231], v6, s[12:15], s50 offen offset:256 sc1
  v_pk_mul_f32 v[204:205], v[80:81], v[80:81]
  v_pk_mul_f32 v[206:207], v[82:83], v[82:83]
  v_pk_mul_f32 v[208:209], v[84:85], v[84:85]
  v_pk_mul_f32 v[210:211], v[86:87], v[86:87]
  v_pk_fma_f32 v[204:205], v[204:205], v[198:199], v[198:199] op_sel:[0,0,1] op_sel_hi:[1,0,1]
  v_pk_fma_f32 v[206:207], v[206:207], v[198:199], v[198:199] op_sel:[0,0,1] op_sel_hi:[1,0,1]
  v_pk_fma_f32 v[208:209], v[208:209], v[198:199], v[198:199] op_sel:[0,0,1] op_sel_hi:[1,0,1]
  v_pk_fma_f32 v[210:211], v[210:211], v[198:199], v[198:199] op_sel:[0,0,1] op_sel_hi:[1,0,1]
  v_pk_mul_f32 v[204:205], v[204:205], v[80:81]
  v_pk_mul_f32 v[206:207], v[206:207], v[82:83]
  v_pk_mul_f32 v[208:209], v[208:209], v[84:85]
  v_pk_mul_f32 v[210:211], v[210:211], v[86:87]
  v_exp_f32 v204, v204
  v_exp_f32 v205, v205
  v_exp_f32 v206, v206
  v_exp_f32 v207, v207
  v_exp_f32 v208, v208
  v_exp_f32 v209, v209
  v_exp_f32 v210, v210
  v_exp_f32 v211, v211
  v_pk_fma_f32 v[204:205], v[204:205], v[202:203], v[202:203] op_sel_hi:[1,0,0]
  v_pk_fma_f32 v[206:207], v[206:207], v[202:203], v[202:203] op_sel_hi:[1,0,0]
  v_pk_fma_f32 v[208:209], v[208:209], v[202:203], v[202:203] op_sel_hi:[1,0,0]
  v_pk_fma_f32 v[210:211], v[210:211], v[202:203], v[202:203] op_sel_hi:[1,0,0]
  v_rcp_f32 v204, v204
  v_rcp_f32 v205, v205
  v_rcp_f32 v206, v206
  v_rcp_f32 v207, v207
  v_rcp_f32 v208, v208
  v_rcp_f32 v209, v209
  v_rcp_f32 v210, v210
  v_rcp_f32 v211, v211
  v_pk_mul_f32 v[204:205], v[204:205], v[80:81]
  v_pk_mul_f32 v[206:207], v[206:207], v[82:83]
  v_pk_mul_f32 v[208:209], v[208:209], v[84:85]
  v_pk_mul_f32 v[210:211], v[210:211], v[86:87]
  v_cvt_pk_bf16_f32 v232, v204, v205
  v_cvt_pk_bf16_f32 v233, v206, v207
  v_cvt_pk_bf16_f32 v234, v208, v209
  v_cvt_pk_bf16_f32 v235, v210, v211
  buffer_store_dwordx4 v[232:235], v6, s[12:15], s51 offen offset:0 sc1
  v_pk_mul_f32 v[204:205], v[88:89], v[88:89]
  v_pk_mul_f32 v[206:207], v[90:91], v[90:91]
  v_pk_mul_f32 v[208:209], v[92:93], v[92:93]
  v_pk_mul_f32 v[210:211], v[94:95], v[94:95]
  v_pk_fma_f32 v[204:205], v[204:205], v[198:199], v[198:199] op_sel:[0,0,1] op_sel_hi:[1,0,1]
  v_pk_fma_f32 v[206:207], v[206:207], v[198:199], v[198:199] op_sel:[0,0,1] op_sel_hi:[1,0,1]
  v_pk_fma_f32 v[208:209], v[208:209], v[198:199], v[198:199] op_sel:[0,0,1] op_sel_hi:[1,0,1]
  v_pk_fma_f32 v[210:211], v[210:211], v[198:199], v[198:199] op_sel:[0,0,1] op_sel_hi:[1,0,1]
  v_pk_mul_f32 v[204:205], v[204:205], v[88:89]
  v_pk_mul_f32 v[206:207], v[206:207], v[90:91]
  v_pk_mul_f32 v[208:209], v[208:209], v[92:93]
  v_pk_mul_f32 v[210:211], v[210:211], v[94:95]
  v_exp_f32 v204, v204
  v_exp_f32 v205, v205
  v_exp_f32 v206, v206
  v_exp_f32 v207, v207
  v_exp_f32 v208, v208
  v_exp_f32 v209, v209
  v_exp_f32 v210, v210
  v_exp_f32 v211, v211
  v_pk_fma_f32 v[204:205], v[204:205], v[202:203], v[202:203] op_sel_hi:[1,0,0]
  v_pk_fma_f32 v[206:207], v[206:207], v[202:203], v[202:203] op_sel_hi:[1,0,0]
  v_pk_fma_f32 v[208:209], v[208:209], v[202:203], v[202:203] op_sel_hi:[1,0,0]
  v_pk_fma_f32 v[210:211], v[210:211], v[202:203], v[202:203] op_sel_hi:[1,0,0]
  v_rcp_f32 v204, v204
  v_rcp_f32 v205, v205
  v_rcp_f32 v206, v206
  v_rcp_f32 v207, v207
  v_rcp_f32 v208, v208
  v_rcp_f32 v209, v209
  v_rcp_f32 v210, v210
  v_rcp_f32 v211, v211
  v_pk_mul_f32 v[204:205], v[204:205], v[88:89]
  v_pk_mul_f32 v[206:207], v[206:207], v[90:91]
  v_pk_mul_f32 v[208:209], v[208:209], v[92:93]
  v_pk_mul_f32 v[210:211], v[210:211], v[94:95]
  v_cvt_pk_bf16_f32 v236, v204, v205
  v_cvt_pk_bf16_f32 v237, v206, v207
  v_cvt_pk_bf16_f32 v238, v208, v209
  v_cvt_pk_bf16_f32 v239, v210, v211
  buffer_store_dwordx4 v[236:239], v6, s[12:15], s51 offen offset:256 sc1
  v_pk_mul_f32 v[204:205], v[96:97], v[96:97]
  v_pk_mul_f32 v[206:207], v[98:99], v[98:99]
  v_pk_mul_f32 v[208:209], v[100:101], v[100:101]
  v_pk_mul_f32 v[210:211], v[102:103], v[102:103]
  v_pk_fma_f32 v[204:205], v[204:205], v[196:197], v[196:197] op_sel:[0,0,1] op_sel_hi:[1,0,1]
  v_pk_fma_f32 v[206:207], v[206:207], v[196:197], v[196:197] op_sel:[0,0,1] op_sel_hi:[1,0,1]
  v_pk_fma_f32 v[208:209], v[208:209], v[196:197], v[196:197] op_sel:[0,0,1] op_sel_hi:[1,0,1]
  v_pk_fma_f32 v[210:211], v[210:211], v[196:197], v[196:197] op_sel:[0,0,1] op_sel_hi:[1,0,1]
  v_pk_mul_f32 v[204:205], v[204:205], v[96:97]
  v_pk_mul_f32 v[206:207], v[206:207], v[98:99]
  v_pk_mul_f32 v[208:209], v[208:209], v[100:101]
  v_pk_mul_f32 v[210:211], v[210:211], v[102:103]
  v_exp_f32 v204, v204
  v_exp_f32 v205, v205
  v_exp_f32 v206, v206
  v_exp_f32 v207, v207
  v_exp_f32 v208, v208
  v_exp_f32 v209, v209
  v_exp_f32 v210, v210
  v_exp_f32 v211, v211
  v_pk_fma_f32 v[204:205], v[204:205], v[200:201], v[200:201] op_sel_hi:[1,0,0]
  v_pk_fma_f32 v[206:207], v[206:207], v[200:201], v[200:201] op_sel_hi:[1,0,0]
  v_pk_fma_f32 v[208:209], v[208:209], v[200:201], v[200:201] op_sel_hi:[1,0,0]
  v_pk_fma_f32 v[210:211], v[210:211], v[200:201], v[200:201] op_sel_hi:[1,0,0]
  v_rcp_f32 v204, v204
  v_rcp_f32 v205, v205
  v_rcp_f32 v206, v206
  v_rcp_f32 v207, v207
  v_rcp_f32 v208, v208
  v_rcp_f32 v209, v209
  v_rcp_f32 v210, v210
  v_rcp_f32 v211, v211
  v_pk_mul_f32 v[204:205], v[204:205], v[96:97]
  v_pk_mul_f32 v[206:207], v[206:207], v[98:99]
  v_pk_mul_f32 v[208:209], v[208:209], v[100:101]
  v_pk_mul_f32 v[210:211], v[210:211], v[102:103]
  v_cvt_pk_bf16_f32 v224, v204, v205
  v_cvt_pk_bf16_f32 v225, v206, v207
  v_cvt_pk_bf16_f32 v226, v208, v209
  v_cvt_pk_bf16_f32 v227, v210, v211
  buffer_store_dwordx4 v[224:227], v6, s[12:15], s52 offen offset:0 sc1
  v_pk_mul_f32 v[204:205], v[104:105], v[104:105]
  v_pk_mul_f32 v[206:207], v[106:107], v[106:107]
  v_pk_mul_f32 v[208:209], v[108:109], v[108:109]
  v_pk_mul_f32 v[210:211], v[110:111], v[110:111]
  v_pk_fma_f32 v[204:205], v[204:205], v[196:197], v[196:197] op_sel:[0,0,1] op_sel_hi:[1,0,1]
  v_pk_fma_f32 v[206:207], v[206:207], v[196:197], v[196:197] op_sel:[0,0,1] op_sel_hi:[1,0,1]
  v_pk_fma_f32 v[208:209], v[208:209], v[196:197], v[196:197] op_sel:[0,0,1] op_sel_hi:[1,0,1]
  v_pk_fma_f32 v[210:211], v[210:211], v[196:197], v[196:197] op_sel:[0,0,1] op_sel_hi:[1,0,1]
  v_pk_mul_f32 v[204:205], v[204:205], v[104:105]
  v_pk_mul_f32 v[206:207], v[206:207], v[106:107]
  v_pk_mul_f32 v[208:209], v[208:209], v[108:109]
  v_pk_mul_f32 v[210:211], v[210:211], v[110:111]
  v_exp_f32 v204, v204
  v_exp_f32 v205, v205
  v_exp_f32 v206, v206
  v_exp_f32 v207, v207
  v_exp_f32 v208, v208
  v_exp_f32 v209, v209
  v_exp_f32 v210, v210
  v_exp_f32 v211, v211
  v_pk_fma_f32 v[204:205], v[204:205], v[200:201], v[200:201] op_sel_hi:[1,0,0]
  v_pk_fma_f32 v[206:207], v[206:207], v[200:201], v[200:201] op_sel_hi:[1,0,0]
  v_pk_fma_f32 v[208:209], v[208:209], v[200:201], v[200:201] op_sel_hi:[1,0,0]
  v_pk_fma_f32 v[210:211], v[210:211], v[200:201], v[200:201] op_sel_hi:[1,0,0]
  v_rcp_f32 v204, v204
  v_rcp_f32 v205, v205
  v_rcp_f32 v206, v206
  v_rcp_f32 v207, v207
  v_rcp_f32 v208, v208
  v_rcp_f32 v209, v209
  v_rcp_f32 v210, v210
  v_rcp_f32 v211, v211
  v_pk_mul_f32 v[204:205], v[204:205], v[104:105]
  v_pk_mul_f32 v[206:207], v[206:207], v[106:107]
  v_pk_mul_f32 v[208:209], v[208:209], v[108:109]
  v_pk_mul_f32 v[210:211], v[210:211], v[110:111]
  v_cvt_pk_bf16_f32 v228, v204, v205
  v_cvt_pk_bf16_f32 v229, v206, v207
  v_cvt_pk_bf16_f32 v230, v208, v209
  v_cvt_pk_bf16_f32 v231, v210, v211
  buffer_store_dwordx4 v[228:231], v6, s[12:15], s52 offen offset:256 sc1
  s_waitcnt vmcnt(6)
  ds_read_b64_tr_b16 v[32:33], v29 offset:0
  ds_read_b64_tr_b16 v[34:35], v29 offset:256
  ds_read_b64_tr_b16 v[36:37], v29 offset:1024
  ds_read_b64_tr_b16 v[38:39], v29 offset:1280
  ds_read_b64_tr_b16 v[40:41], v29 offset:2048
  ds_read_b64_tr_b16 v[42:43], v29 offset:2304
  v_pk_mul_f32 v[204:205], v[112:113], v[112:113]
  v_pk_mul_f32 v[206:207], v[114:115], v[114:115]
  v_pk_mul_f32 v[208:209], v[116:117], v[116:117]
  v_pk_mul_f32 v[210:211], v[118:119], v[118:119]
  v_pk_fma_f32 v[204:205], v[204:205], v[198:199], v[198:199] op_sel:[0,0,1] op_sel_hi:[1,0,1]
  v_pk_fma_f32 v[206:207], v[206:207], v[198:199], v[198:199] op_sel:[0,0,1] op_sel_hi:[1,0,1]
  v_pk_fma_f32 v[208:209], v[208:209], v[198:199], v[198:199] op_sel:[0,0,1] op_sel_hi:[1,0,1]
  v_pk_fma_f32 v[210:211], v[210:211], v[198:199], v[198:199] op_sel:[0,0,1] op_sel_hi:[1,0,1]
  v_pk_mul_f32 v[204:205], v[204:205], v[112:113]
  v_pk_mul_f32 v[206:207], v[206:207], v[114:115]
  v_pk_mul_f32 v[208:209], v[208:209], v[116:117]
  v_pk_mul_f32 v[210:211], v[210:211], v[118:119]
  v_exp_f32 v204, v204
  v_exp_f32 v205, v205
  v_exp_f32 v206, v206
  v_exp_f32 v207, v207
  v_exp_f32 v208, v208
  v_exp_f32 v209, v209
  v_exp_f32 v210, v210
  v_exp_f32 v211, v211
  v_pk_fma_f32 v[204:205], v[204:205], v[202:203], v[202:203] op_sel_hi:[1,0,0]
  v_pk_fma_f32 v[206:207], v[206:207], v[202:203], v[202:203] op_sel_hi:[1,0,0]
  v_pk_fma_f32 v[208:209], v[208:209], v[202:203], v[202:203] op_sel_hi:[1,0,0]
  v_pk_fma_f32 v[210:211], v[210:211], v[202:203], v[202:203] op_sel_hi:[1,0,0]
  v_rcp_f32 v204, v204
  v_rcp_f32 v205, v205
  v_rcp_f32 v206, v206
  v_rcp_f32 v207, v207
  v_rcp_f32 v208, v208
  v_rcp_f32 v209, v209
  v_rcp_f32 v210, v210
  v_rcp_f32 v211, v211
  v_pk_mul_f32 v[204:205], v[204:205], v[112:113]
  v_pk_mul_f32 v[206:207], v[206:207], v[114:115]
  v_pk_mul_f32 v[208:209], v[208:209], v[116:117]
  v_pk_mul_f32 v[210:211], v[210:211], v[118:119]
  v_cvt_pk_bf16_f32 v232, v204, v205
  v_cvt_pk_bf16_f32 v233, v206, v207
  v_cvt_pk_bf16_f32 v234, v208, v209
  v_cvt_pk_bf16_f32 v235, v210, v211
  buffer_store_dwordx4 v[232:235], v6, s[12:15], s53 offen offset:0 sc1
  s_waitcnt lgkmcnt(0)
  buffer_store_dwordx4 v[32:35], v30, s[12:15], s57 offen sc1
  buffer_store_dwordx4 v[36:39], v30, s[12:15], s58 offen sc1
  buffer_store_dwordx4 v[40:43], v30, s[12:15], s59 offen sc1
  v_pk_mul_f32 v[204:205], v[120:121], v[120:121]
  v_pk_mul_f32 v[206:207], v[122:123], v[122:123]
  v_pk_mul_f32 v[208:209], v[124:125], v[124:125]
  v_pk_mul_f32 v[210:211], v[126:127], v[126:127]
  v_pk_fma_f32 v[204:205], v[204:205], v[198:199], v[198:199] op_sel:[0,0,1] op_sel_hi:[1,0,1]
  v_pk_fma_f32 v[206:207], v[206:207], v[198:199], v[198:199] op_sel:[0,0,1] op_sel_hi:[1,0,1]
  v_pk_fma_f32 v[208:209], v[208:209], v[198:199], v[198:199] op_sel:[0,0,1] op_sel_hi:[1,0,1]
  v_pk_fma_f32 v[210:211], v[210:211], v[198:199], v[198:199] op_sel:[0,0,1] op_sel_hi:[1,0,1]
  v_pk_mul_f32 v[204:205], v[204:205], v[120:121]
  v_pk_mul_f32 v[206:207], v[206:207], v[122:123]
  v_pk_mul_f32 v[208:209], v[208:209], v[124:125]
  v_pk_mul_f32 v[210:211], v[210:211], v[126:127]
  v_exp_f32 v204, v204
  v_exp_f32 v205, v205
  v_exp_f32 v206, v206
  v_exp_f32 v207, v207
  v_exp_f32 v208, v208
  v_exp_f32 v209, v209
  v_exp_f32 v210, v210
  v_exp_f32 v211, v211
  v_pk_fma_f32 v[204:205], v[204:205], v[202:203], v[202:203] op_sel_hi:[1,0,0]
  v_pk_fma_f32 v[206:207], v[206:207], v[202:203], v[202:203] op_sel_hi:[1,0,0]
  v_pk_fma_f32 v[208:209], v[208:209], v[202:203], v[202:203] op_sel_hi:[1,0,0]
  v_pk_fma_f32 v[210:211], v[210:211], v[202:203], v[202:203] op_sel_hi:[1,0,0]
  v_rcp_f32 v204, v204
  v_rcp_f32 v205, v205
  v_rcp_f32 v206, v206
  v_rcp_f32 v207, v207
  v_rcp_f32 v208, v208
  v_rcp_f32 v209, v209
  v_rcp_f32 v210, v210
  v_rcp_f32 v211, v211
  v_pk_mul_f32 v[204:205], v[204:205], v[120:121]
  v_pk_mul_f32 v[206:207], v[206:207], v[122:123]
  v_pk_mul_f32 v[208:209], v[208:209], v[124:125]
  v_pk_mul_f32 v[210:211], v[210:211], v[126:127]
  v_cvt_pk_bf16_f32 v236, v204, v205
  v_cvt_pk_bf16_f32 v237, v206, v207
  v_cvt_pk_bf16_f32 v238, v208, v209
  v_cvt_pk_bf16_f32 v239, v210, v211
  buffer_store_dwordx4 v[236:239], v6, s[12:15], s53 offen offset:256 sc1
G1_done:
  s_endpgm
L_role:
  s_cmp_lt_u32 s2, 32
  s_cselect_b32 s3, 0, 224
  s_sub_u32 s3, s2, s3
  s_load_dwordx2 s[8:9], s[0:1], 0
  s_load_dwordx2 s[12:13], s[0:1], 128
  s_mov_b32 s10, 2621440
  s_mov_b32 s11, 0x20000
  s_mov_b32 s14, 19922944
  s_mov_b32 s15, 0x20000
  v_lshrrev_b32 v1, 4, v0
  v_and_b32 v2, 15, v0
  v_mul_u32_u24 v3, 1280, v1
  v_lshl_add_u32 v3, v2, 4, v3
  s_and_b32 s56, s3, 7
  s_lshr_b32 s57, s3, 3
  s_lshl_b32 s58, s56, 4
  s_add_u32 s58, s58, s57
  s_mul_i32 s28, s58, 20480
  v_lshrrev_b32 v4, 6, v0
  s_add_u32 s50, s28, 163840
  v_readfirstlane_b32 s29, v4
  s_waitcnt lgkmcnt(0)
  s_cmp_lt_u32 s3, 16
  s_cbranch_scc0 L_nocpf
  s_getpc_b64 s[52:53]
L_pc:
  s_sub_u32 s52, s52, L_pc-k1_kernel
  s_subb_u32 s53, s53, 0
  s_mov_b32 s54, k2_end-k1_kernel
  s_mov_b32 s55, 0x20000
  s_lshl_b32 s57, s57, 15
  v_lshlrev_b32 v9, 7, v0
  v_add_u32 v9, s57, v9
  buffer_load_dword v132, v9, s[52:55], 0 offen
L_nocpf:
  buffer_load_dwordx4 v[16:19], v3, s[8:11], s28 offen offset:0
  buffer_load_dwordx4 v[20:23], v3, s[8:11], s28 offen offset:256
  buffer_load_dwordx4 v[24:27], v3, s[8:11], s28 offen offset:512
  buffer_load_dwordx4 v[28:31], v3, s[8:11], s28 offen offset:768
  buffer_load_dwordx4 v[32:35], v3, s[8:11], s28 offen offset:1024
  buffer_load_dwordx4 v[144:147], v3, s[8:11], s50 offen offset:0
  buffer_load_dwordx4 v[148:151], v3, s[8:11], s50 offen offset:256
  buffer_load_dwordx4 v[152:155], v3, s[8:11], s50 offen offset:512
  buffer_load_dwordx4 v[156:159], v3, s[8:11], s50 offen offset:768
  buffer_load_dwordx4 v[160:163], v3, s[8:11], s50 offen offset:1024
  v_mul_u32_u24 v36, 1312, v1
  v_lshl_add_u32 v36, v2, 4, v36
  v_bfe_u32 v1, v0, 2, 2
  v_and_b32 v2, 3, v0
  v_bfe_u32 v3, v0, 4, 1
  v_bfe_u32 v4, v0, 5, 1
  v_lshl_add_u32 v5, v3, 3, v1
  v_mul_u32_u24 v5, 1312, v5
  v_lshl_add_u32 v5, v2, 3, v5
  v_lshl_add_u32 v5, v4, 5, v5
  s_mul_i32 s46, s29, 320
  v_add_u32 v5, s46, v5
  v_and_b32 v6, 15, v0
  v_lshl_add_u32 v6, v4, 4, v6
  v_lshlrev_b32 v6, 5, v6
  v_lshl_add_u32 v6, v3, 4, v6
  s_mul_i32 s47, s29, 5120
  s_add_u32 s47, s47, s28
  s_add_u32 s47, s47, 9961472
  s_waitcnt vmcnt(5)
  s_cmp_lg_u32 s29, 3
  s_cbranch_scc1 L_nopp
  s_load_dwordx2 s[60:61], s[0:1], 8
  s_mov_b32 s62, 163840
  s_mov_b32 s63, 0x20000
  s_load_dwordx2 s[64:65], s[0:1], 16
  s_mov_b32 s66, 163840
  s_mov_b32 s67, 0x20000
  s_load_dwordx2 s[68:69], s[0:1], 24
  s_mov_b32 s70, 163840
  s_mov_b32 s71, 0x20000
  s_load_dwordx2 s[72:73], s[0:1], 32
  s_mov_b32 s74, 163840
  s_mov_b32 s75, 0x20000
  s_load_dwordx2 s[40:41], s[0:1], 40
  s_mov_b32 s42, 163840
  s_mov_b32 s43, 0x20000
  s_load_dwordx2 s[16:17], s[0:1], 48
  s_mov_b32 s18, 163840
  s_mov_b32 s19, 0x20000
  s_load_dwordx2 s[24:25], s[0:1], 56
  s_load_dwordx2 s[4:5], s[0:1], 64
  s_mov_b32 s26, 1280
  s_mov_b32 s27, 0x20000
  s_mov_b32 s6, 1280
  s_mov_b32 s7, 0x20000
  v_and_b32 v9, 7, v0
  v_lshlrev_b32 v9, 7, v9
  v_bfe_u32 v10, v0, 3, 3
  v_lshl_add_u32 v9, v10, 16, v9
  v_and_b32 v10, 63, v0
  v_lshlrev_b32 v10, 7, v10
  s_lshl_b32 s31, s3, 10
  v_add_u32 v9, s31, v9
  s_waitcnt lgkmcnt(0)
  buffer_load_dword v133, v9, s[60:63], 0 offen
  buffer_load_dword v134, v9, s[64:67], 0 offen
  buffer_load_dword v135, v9, s[68:71], 0 offen
  buffer_load_dword v136, v9, s[72:75], 0 offen
  buffer_load_dword v137, v9, s[40:43], 0 offen
  buffer_load_dword v138, v9, s[16:19], 0 offen
  buffer_load_dword v139, v10, s[24:27], 0 offen
  buffer_load_dword v140, v10, s[4:7], 0 offen
L_nopp:
  s_cmp_eq_u32 s3, 63
  s_cbranch_scc0 L_nz
  v_mov_b32 v40, 0
  v_mov_b32 v41, 0
  v_mov_b32 v42, 0
  v_mov_b32 v43, 0
  v_lshlrev_b32 v9, 4, v0
  s_mov_b32 s30, 19005440
  buffer_store_dwordx4 v[40:43], v9, s[12:15], s30 offen sc1
  s_add_u32 s30, s30, 4096
  buffer_store_dwordx4 v[40:43], v9, s[12:15], s30 offen sc1
L_nz:
L_iter:
  v_lshlrev_b32 v64, 16, v16
  v_and_b32 v65, 0xffff0000, v16
  v_lshlrev_b32 v66, 16, v17
  v_and_b32 v67, 0xffff0000, v17
  v_pk_add_f32 v[104:105], v[64:65], v[66:67]
  v_lshlrev_b32 v68, 16, v18
  v_and_b32 v69, 0xffff0000, v18
  v_lshlrev_b32 v70, 16, v19
  v_and_b32 v71, 0xffff0000, v19
  v_pk_add_f32 v[106:107], v[68:69], v[70:71]
  v_lshlrev_b32 v72, 16, v20
  v_and_b32 v73, 0xffff0000, v20
  v_pk_add_f32 v[104:105], v[104:105], v[72:73]
  v_lshlrev_b32 v74, 16, v21
  v_and_b32 v75, 0xffff0000, v21
  v_pk_add_f32 v[106:107], v[106:107], v[74:75]
  v_lshlrev_b32 v76, 16, v22
  v_and_b32 v77, 0xffff0000, v22
  v_pk_add_f32 v[104:105], v[104:105], v[76:77]
  v_lshlrev_b32 v78, 16, v23
  v_and_b32 v79, 0xffff0000, v23
  v_pk_add_f32 v[106:107], v[106:107], v[78:79]
  v_lshlrev_b32 v80, 16, v24
  v_and_b32 v81, 0xffff0000, v24
  v_pk_add_f32 v[104:105], v[104:105], v[80:81]
  v_lshlrev_b32 v82, 16, v25
  v_and_b32 v83, 0xffff0000, v25
  v_pk_add_f32 v[106:107], v[106:107], v[82:83]
  v_lshlrev_b32 v84, 16, v26
  v_and_b32 v85, 0xffff0000, v26
  v_pk_add_f32 v[104:105], v[104:105], v[84:85]
  v_lshlrev_b32 v86, 16, v27
  v_and_b32 v87, 0xffff0000, v27
  v_pk_add_f32 v[106:107], v[106:107], v[86:87]
  v_lshlrev_b32 v88, 16, v28
  v_and_b32 v89, 0xffff0000, v28
  v_pk_add_f32 v[104:105], v[104:105], v[88:89]
  v_lshlrev_b32 v90, 16, v29
  v_and_b32 v91, 0xffff0000, v29
  v_pk_add_f32 v[106:107], v[106:107], v[90:91]
  v_lshlrev_b32 v92, 16, v30
  v_and_b32 v93, 0xffff0000, v30
  v_pk_add_f32 v[104:105], v[104:105], v[92:93]
  v_lshlrev_b32 v94, 16, v31
  v_and_b32 v95, 0xffff0000, v31
  v_pk_add_f32 v[106:107], v[106:107], v[94:95]
  v_lshlrev_b32 v96, 16, v32
  v_and_b32 v97, 0xffff0000, v32
  v_pk_add_f32 v[104:105], v[104:105], v[96:97]
  v_lshlrev_b32 v98, 16, v33
  v_and_b32 v99, 0xffff0000, v33
  v_pk_add_f32 v[106:107], v[106:107], v[98:99]
  v_lshlrev_b32 v100, 16, v34
  v_and_b32 v101, 0xffff0000, v34
  v_pk_add_f32 v[104:105], v[104:105], v[100:101]
  v_lshlrev_b32 v102, 16, v35
  v_and_b32 v103, 0xffff0000, v35
  v_pk_add_f32 v[106:107], v[106:107], v[102:103]
  v_pk_add_f32 v[104:105], v[104:105], v[106:107]
  v_add_f32 v10, v104, v105
  s_nop 1
  v_add_f32_dpp v10, v10, v10 row_ror:8 row_mask:0xf bank_mask:0xf
  s_nop 1
  v_add_f32_dpp v10, v10, v10 row_ror:4 row_mask:0xf bank_mask:0xf
  s_nop 1
  v_add_f32_dpp v10, v10, v10 row_ror:2 row_mask:0xf bank_mask:0xf
  s_nop 1
  v_add_f32_dpp v10, v10, v10 row_ror:1 row_mask:0xf bank_mask:0xf
  v_mul_f32 v10, 0x3acccccd, v10
  v_pk_add_f32 v[116:117], v[64:65], v[10:11] op_sel_hi:[1,0] neg_lo:[0,1] neg_hi:[0,1]
  v_pk_mul_f32 v[104:105], v[116:117], v[116:117]
  v_pk_add_f32 v[118:119], v[66:67], v[10:11] op_sel_hi:[1,0] neg_lo:[0,1] neg_hi:[0,1]
  v_pk_mul_f32 v[106:107], v[118:119], v[118:119]
  v_pk_add_f32 v[120:121], v[68:69], v[10:11] op_sel_hi:[1,0] neg_lo:[0,1] neg_hi:[0,1]
  v_pk_fma_f32 v[104:105], v[120:121], v[120:121], v[104:105]
  v_pk_add_f32 v[122:123], v[70:71], v[10:11] op_sel_hi:[1,0] neg_lo:[0,1] neg_hi:[0,1]
  v_pk_fma_f32 v[106:107], v[122:123], v[122:123], v[106:107]
  v_pk_add_f32 v[116:117], v[72:73], v[10:11] op_sel_hi:[1,0] neg_lo:[0,1] neg_hi:[0,1]
  v_pk_fma_f32 v[104:105], v[116:117], v[116:117], v[104:105]
  v_pk_add_f32 v[118:119], v[74:75], v[10:11] op_sel_hi:[1,0] neg_lo:[0,1] neg_hi:[0,1]
  v_pk_fma_f32 v[106:107], v[118:119], v[118:119], v[106:107]
  v_pk_add_f32 v[120:121], v[76:77], v[10:11] op_sel_hi:[1,0] neg_lo:[0,1] neg_hi:[0,1]
  v_pk_fma_f32 v[104:105], v[120:121], v[120:121], v[104:105]
  v_pk_add_f32 v[122:123], v[78:79], v[10:11] op_sel_hi:[1,0] neg_lo:[0,1] neg_hi:[0,1]
  v_pk_fma_f32 v[106:107], v[122:123], v[122:123], v[106:107]
  v_pk_add_f32 v[116:117], v[80:81], v[10:11] op_sel_hi:[1,0] neg_lo:[0,1] neg_hi:[0,1]
  v_pk_fma_f32 v[104:105], v[116:117], v[116:117], v[104:105]
  v_pk_add_f32 v[118:119], v[82:83], v[10:11] op_sel_hi:[1,0] neg_lo:[0,1] neg_hi:[0,1]
  v_pk_fma_f32 v[106:107], v[118:119], v[118:119], v[106:107]
  v_pk_add_f32 v[120:121], v[84:85], v[10:11] op_sel_hi:[1,0] neg_lo:[0,1] neg_hi:[0,1]
  v_pk_fma_f32 v[104:105], v[120:121], v[120:121], v[104:105]
  v_pk_add_f32 v[122:123], v[86:87], v[10:11] op_sel_hi:[1,0] neg_lo:[0,1] neg_hi:[0,1]
  v_pk_fma_f32 v[106:107], v[122:123], v[122:123], v[106:107]
  v_pk_add_f32 v[116:117], v[88:89], v[10:11] op_sel_hi:[1,0] neg_lo:[0,1] neg_hi:[0,1]
  v_pk_fma_f32 v[104:105], v[116:117], v[116:117], v[104:105]
  v_pk_add_f32 v[118:119], v[90:91], v[10:11] op_sel_hi:[1,0] neg_lo:[0,1] neg_hi:[0,1]
  v_pk_fma_f32 v[106:107], v[118:119], v[118:119], v[106:107]
  v_pk_add_f32 v[120:121], v[92:93], v[10:11] op_sel_hi:[1,0] neg_lo:[0,1] neg_hi:[0,1]
  v_pk_fma_f32 v[104:105], v[120:121], v[120:121], v[104:105]
  v_pk_add_f32 v[122:123], v[94:95], v[10:11] op_sel_hi:[1,0] neg_lo:[0,1] neg_hi:[0,1]
  v_pk_fma_f32 v[106:107], v[122:123], v[122:123], v[106:107]
  v_pk_add_f32 v[116:117], v[96:97], v[10:11] op_sel_hi:[1,0] neg_lo:[0,1] neg_hi:[0,1]
  v_pk_fma_f32 v[104:105], v[116:117], v[116:117], v[104:105]
  v_pk_add_f32 v[118:119], v[98:99], v[10:11] op_sel_hi:[1,0] neg_lo:[0,1] neg_hi:[0,1]
  v_pk_fma_f32 v[106:107], v[118:119], v[118:119], v[106:107]
  v_pk_add_f32 v[120:121], v[100:101], v[10:11] op_sel_hi:[1,0] neg_lo:[0,1] neg_hi:[0,1]
  v_pk_fma_f32 v[104:105], v[120:121], v[120:121], v[104:105]
  v_pk_add_f32 v[122:123], v[102:103], v[10:11] op_sel_hi:[1,0] neg_lo:[0,1] neg_hi:[0,1]
  v_pk_fma_f32 v[106:107], v[122:123], v[122:123], v[106:107]
  v_pk_add_f32 v[104:105], v[104:105], v[106:107]
  v_add_f32 v11, v104, v105
  s_nop 1
  v_add_f32_dpp v11, v11, v11 row_ror:8 row_mask:0xf bank_mask:0xf
  s_nop 1
  v_add_f32_dpp v11, v11, v11 row_ror:4 row_mask:0xf bank_mask:0xf
  s_nop 1
  v_add_f32_dpp v11, v11, v11 row_ror:2 row_mask:0xf bank_mask:0xf
  s_nop 1
  v_add_f32_dpp v11, v11, v11 row_ror:1 row_mask:0xf bank_mask:0xf
  v_mul_f32 v11, 0x3acccccd, v11
  v_cvt_pk_bf16_f32 v15, v11, v11
  v_and_b32 v15, 0xffff0000, v15
  v_cvt_pk_bf16_f32 v12, v10, v10
  v_and_b32 v12, 0xffff0000, v12
  v_add_f32 v15, 0x3727c5ac, v15
  v_cvt_pk_bf16_f32 v15, v15, v15
  v_and_b32 v15, 0xffff0000, v15
  v_sqrt_f32 v15, v15
  s_nop 0
  v_cvt_pk_bf16_f32 v13, v15, v15
  v_and_b32 v13, 0xffff0000, v13
  v_rcp_f32 v14, v13
  v_pk_add_f32 v[116:117], v[64:65], v[12:13] op_sel_hi:[1,0] neg_lo:[0,1] neg_hi:[0,1]
  v_cvt_pk_bf16_f32 v116, v116, v117
  v_and_b32 v117, 0xffff0000, v116
  v_lshlrev_b32 v116, 16, v116
  v_pk_mul_f32 v[116:117], v[116:117], v[14:15] op_sel_hi:[1,0]
  v_cvt_pk_bf16_f32 v16, v116, v117
  v_pk_add_f32 v[118:119], v[66:67], v[12:13] op_sel_hi:[1,0] neg_lo:[0,1] neg_hi:[0,1]
  v_cvt_pk_bf16_f32 v118, v118, v119
  v_and_b32 v119, 0xffff0000, v118
  v_lshlrev_b32 v118, 16, v118
  v_pk_mul_f32 v[118:119], v[118:119], v[14:15] op_sel_hi:[1,0]
  v_cvt_pk_bf16_f32 v17, v118, v119
  v_pk_add_f32 v[120:121], v[68:69], v[12:13] op_sel_hi:[1,0] neg_lo:[0,1] neg_hi:[0,1]
  v_cvt_pk_bf16_f32 v120, v120, v121
  v_and_b32 v121, 0xffff0000, v120
  v_lshlrev_b32 v120, 16, v120
  v_pk_mul_f32 v[120:121], v[120:121], v[14:15] op_sel_hi:[1,0]
  v_cvt_pk_bf16_f32 v18, v120, v121
  v_pk_add_f32 v[122:123], v[70:71], v[12:13] op_sel_hi:[1,0] neg_lo:[0,1] neg_hi:[0,1]
  v_cvt_pk_bf16_f32 v122, v122, v123
  v_and_b32 v123, 0xffff0000, v122
  v_lshlrev_b32 v122, 16, v122
  v_pk_mul_f32 v[122:123], v[122:123], v[14:15] op_sel_hi:[1,0]
  v_cvt_pk_bf16_f32 v19, v122, v123
  ds_write_b128 v36, v[16:19] offset:0
  v_pk_add_f32 v[116:117], v[72:73], v[12:13] op_sel_hi:[1,0] neg_lo:[0,1] neg_hi:[0,1]
  v_cvt_pk_bf16_f32 v116, v116, v117
  v_and_b32 v117, 0xffff0000, v116
  v_lshlrev_b32 v116, 16, v116
  v_pk_mul_f32 v[116:117], v[116:117], v[14:15] op_sel_hi:[1,0]
  v_cvt_pk_bf16_f32 v20, v116, v117
  v_pk_add_f32 v[118:119], v[74:75], v[12:13] op_sel_hi:[1,0] neg_lo:[0,1] neg_hi:[0,1]
  v_cvt_pk_bf16_f32 v118, v118, v119
  v_and_b32 v119, 0xffff0000, v118
  v_lshlrev_b32 v118, 16, v118
  v_pk_mul_f32 v[118:119], v[118:119], v[14:15] op_sel_hi:[1,0]
  v_cvt_pk_bf16_f32 v21, v118, v119
  v_pk_add_f32 v[120:121], v[76:77], v[12:13] op_sel_hi:[1,0] neg_lo:[0,1] neg_hi:[0,1]
  v_cvt_pk_bf16_f32 v120, v120, v121
  v_and_b32 v121, 0xffff0000, v120
  v_lshlrev_b32 v120, 16, v120
  v_pk_mul_f32 v[120:121], v[120:121], v[14:15] op_sel_hi:[1,0]
  v_cvt_pk_bf16_f32 v22, v120, v121
  v_pk_add_f32 v[122:123], v[78:79], v[12:13] op_sel_hi:[1,0] neg_lo:[0,1] neg_hi:[0,1]
  v_cvt_pk_bf16_f32 v122, v122, v123
  v_and_b32 v123, 0xffff0000, v122
  v_lshlrev_b32 v122, 16, v122
  v_pk_mul_f32 v[122:123], v[122:123], v[14:15] op_sel_hi:[1,0]
  v_cvt_pk_bf16_f32 v23, v122, v123
  ds_write_b128 v36, v[20:23] offset:256
  v_pk_add_f32 v[116:117], v[80:81], v[12:13] op_sel_hi:[1,0] neg_lo:[0,1] neg_hi:[0,1]
  v_cvt_pk_bf16_f32 v116, v116, v117
  v_and_b32 v117, 0xffff0000, v116
  v_lshlrev_b32 v116, 16, v116
  v_pk_mul_f32 v[116:117], v[116:117], v[14:15] op_sel_hi:[1,0]
  v_cvt_pk_bf16_f32 v24, v116, v117
  v_pk_add_f32 v[118:119], v[82:83], v[12:13] op_sel_hi:[1,0] neg_lo:[0,1] neg_hi:[0,1]
  v_cvt_pk_bf16_f32 v118, v118, v119
  v_and_b32 v119, 0xffff0000, v118
  v_lshlrev_b32 v118, 16, v118
  v_pk_mul_f32 v[118:119], v[118:119], v[14:15] op_sel_hi:[1,0]
  v_cvt_pk_bf16_f32 v25, v118, v119
  v_pk_add_f32 v[120:121], v[84:85], v[12:13] op_sel_hi:[1,0] neg_lo:[0,1] neg_hi:[0,1]
  v_cvt_pk_bf16_f32 v120, v120, v121
  v_and_b32 v121, 0xffff0000, v120
  v_lshlrev_b32 v120, 16, v120
  v_pk_mul_f32 v[120:121], v[120:121], v[14:15] op_sel_hi:[1,0]
  v_cvt_pk_bf16_f32 v26, v120, v121
  v_pk_add_f32 v[122:123], v[86:87], v[12:13] op_sel_hi:[1,0] neg_lo:[0,1] neg_hi:[0,1]
  v_cvt_pk_bf16_f32 v122, v122, v123
  v_and_b32 v123, 0xffff0000, v122
  v_lshlrev_b32 v122, 16, v122
  v_pk_mul_f32 v[122:123], v[122:123], v[14:15] op_sel_hi:[1,0]
  v_cvt_pk_bf16_f32 v27, v122, v123
  ds_write_b128 v36, v[24:27] offset:512
  v_pk_add_f32 v[116:117], v[88:89], v[12:13] op_sel_hi:[1,0] neg_lo:[0,1] neg_hi:[0,1]
  v_cvt_pk_bf16_f32 v116, v116, v117
  v_and_b32 v117, 0xffff0000, v116
  v_lshlrev_b32 v116, 16, v116
  v_pk_mul_f32 v[116:117], v[116:117], v[14:15] op_sel_hi:[1,0]
  v_cvt_pk_bf16_f32 v28, v116, v117
  v_pk_add_f32 v[118:119], v[90:91], v[12:13] op_sel_hi:[1,0] neg_lo:[0,1] neg_hi:[0,1]
  v_cvt_pk_bf16_f32 v118, v118, v119
  v_and_b32 v119, 0xffff0000, v118
  v_lshlrev_b32 v118, 16, v118
  v_pk_mul_f32 v[118:119], v[118:119], v[14:15] op_sel_hi:[1,0]
  v_cvt_pk_bf16_f32 v29, v118, v119
  v_pk_add_f32 v[120:121], v[92:93], v[12:13] op_sel_hi:[1,0] neg_lo:[0,1] neg_hi:[0,1]
  v_cvt_pk_bf16_f32 v120, v120, v121
  v_and_b32 v121, 0xffff0000, v120
  v_lshlrev_b32 v120, 16, v120
  v_pk_mul_f32 v[120:121], v[120:121], v[14:15] op_sel_hi:[1,0]
  v_cvt_pk_bf16_f32 v30, v120, v121
  v_pk_add_f32 v[122:123], v[94:95], v[12:13] op_sel_hi:[1,0] neg_lo:[0,1] neg_hi:[0,1]
  v_cvt_pk_bf16_f32 v122, v122, v123
  v_and_b32 v123, 0xffff0000, v122
  v_lshlrev_b32 v122, 16, v122
  v_pk_mul_f32 v[122:123], v[122:123], v[14:15] op_sel_hi:[1,0]
  v_cvt_pk_bf16_f32 v31, v122, v123
  ds_write_b128 v36, v[28:31] offset:768
  v_pk_add_f32 v[116:117], v[96:97], v[12:13] op_sel_hi:[1,0] neg_lo:[0,1] neg_hi:[0,1]
  v_cvt_pk_bf16_f32 v116, v116, v117
  v_and_b32 v117, 0xffff0000, v116
  v_lshlrev_b32 v116, 16, v116
  v_pk_mul_f32 v[116:117], v[116:117], v[14:15] op_sel_hi:[1,0]
  v_cvt_pk_bf16_f32 v32, v116, v117
  v_pk_add_f32 v[118:119], v[98:99], v[12:13] op_sel_hi:[1,0] neg_lo:[0,1] neg_hi:[0,1]
  v_cvt_pk_bf16_f32 v118, v118, v119
  v_and_b32 v119, 0xffff0000, v118
  v_lshlrev_b32 v118, 16, v118
  v_pk_mul_f32 v[118:119], v[118:119], v[14:15] op_sel_hi:[1,0]
  v_cvt_pk_bf16_f32 v33, v118, v119
  v_pk_add_f32 v[120:121], v[100:101], v[12:13] op_sel_hi:[1,0] neg_lo:[0,1] neg_hi:[0,1]
  v_cvt_pk_bf16_f32 v120, v120, v121
  v_and_b32 v121, 0xffff0000, v120
  v_lshlrev_b32 v120, 16, v120
  v_pk_mul_f32 v[120:121], v[120:121], v[14:15] op_sel_hi:[1,0]
  v_cvt_pk_bf16_f32 v34, v120, v121
  v_pk_add_f32 v[122:123], v[102:103], v[12:13] op_sel_hi:[1,0] neg_lo:[0,1] neg_hi:[0,1]
  v_cvt_pk_bf16_f32 v122, v122, v123
  v_and_b32 v123, 0xffff0000, v122
  v_lshlrev_b32 v122, 16, v122
  v_pk_mul_f32 v[122:123], v[122:123], v[14:15] op_sel_hi:[1,0]
  v_cvt_pk_bf16_f32 v35, v122, v123
  ds_write_b128 v36, v[32:35] offset:1024
  s_waitcnt lgkmcnt(0)
  s_barrier
  ds_read_b64_tr_b16 v[16:17], v5 offset:0
  ds_read_b64_tr_b16 v[18:19], v5 offset:5248
  ds_read_b64_tr_b16 v[20:21], v5 offset:64
  ds_read_b64_tr_b16 v[22:23], v5 offset:5312
  ds_read_b64_tr_b16 v[24:25], v5 offset:128
  ds_read_b64_tr_b16 v[26:27], v5 offset:5376
  ds_read_b64_tr_b16 v[28:29], v5 offset:192
  ds_read_b64_tr_b16 v[30:31], v5 offset:5440
  ds_read_b64_tr_b16 v[32:33], v5 offset:256
  ds_read_b64_tr_b16 v[34:35], v5 offset:5504
  s_waitcnt lgkmcnt(8)
  buffer_store_dwordx4 v[16:19], v6, s[12:15], s47 offen offset:0 sc1
  s_waitcnt lgkmcnt(6)
  buffer_store_dwordx4 v[20:23], v6, s[12:15], s47 offen offset:1024 sc1
  s_waitcnt lgkmcnt(4)
  buffer_store_dwordx4 v[24:27], v6, s[12:15], s47 offen offset:2048 sc1
  s_waitcnt lgkmcnt(2)
  buffer_store_dwordx4 v[28:31], v6, s[12:15], s47 offen offset:3072 sc1
  s_add_u32 s47, s47, 4096
  s_waitcnt lgkmcnt(0)
  buffer_store_dwordx4 v[32:35], v6, s[12:15], s47 offen sc1
L_done:
  s_add_u32 s3, s3, 64
  s_cmp_lt_u32 s3, 128
  s_cbranch_scc0 L_fin
  s_add_u32 s47, s47, 159744
  s_waitcnt vmcnt(5)
  s_barrier
  s_nop 1
  v_mov_b32 v16, v144
  v_mov_b32 v17, v145
  v_mov_b32 v18, v146
  v_mov_b32 v19, v147
  v_mov_b32 v20, v148
  v_mov_b32 v21, v149
  v_mov_b32 v22, v150
  v_mov_b32 v23, v151
  v_mov_b32 v24, v152
  v_mov_b32 v25, v153
  v_mov_b32 v26, v154
  v_mov_b32 v27, v155
  v_mov_b32 v28, v156
  v_mov_b32 v29, v157
  v_mov_b32 v30, v158
  v_mov_b32 v31, v159
  v_mov_b32 v32, v160
  v_mov_b32 v33, v161
  v_mov_b32 v34, v162
  v_mov_b32 v35, v163
  s_branch L_iter
L_fin:
  s_endpgm
k1_end:
.globl k2_kernel
.p2align 8
.type k2_kernel,@function
k2_kernel:
  s_cmp_lt_u32 s2, 160
  s_cbranch_scc1 C_role
  s_cmp_lt_u32 s2, 416
  s_cbranch_scc1 G2_role
k2_exit:
  s_endpgm
G2_role:
  s_load_dwordx2 s[8:9], s[0:1], 128
  s_load_dwordx2 s[16:17], s[0:1], 0
  s_load_dwordx2 s[20:21], s[0:1], 104
  s_load_dwordx2 s[24:25], s[0:1], 112
  s_mov_b32 s10, 19922944
  s_mov_b32 s11, 0x20000
  s_mov_b32 s18, 2621440
  s_mov_b32 s19, 0x20000
  s_mov_b32 s22, 1280
  s_mov_b32 s23, 0x20000
  s_mov_b32 s26, 2621440
  s_mov_b32 s27, 0x20000
  v_lshrrev_b32 v4, 6, v0
  v_and_b32 v1, 63, v0
  s_sub_u32 s28, s2, 160
  v_readfirstlane_b32 s29, v4
  s_and_b32 s30, s28, 7
  s_lshr_b32 s31, s28, 3
  s_and_b32 s32, s31, 3
  s_lshl_b32 s33, s30, 2
  s_add_u32 s33, s33, s32
  s_lshr_b32 s34, s31, 2
  s_mul_i32 s35, s32, 54
  s_mul_i32 s36, s34, 27
  s_add_u32 s35, s35, s36
  s_lshr_b32 s35, s35, 2
  s_mov_b32 s35, 0
  s_add_u32 s35, s35, s29
  s_cmp_ge_u32 s35, 54
  s_cselect_b32 s36, 54, 0
  s_sub_u32 s35, s35, s36
  s_mul_i32 s37, s33, 221184
  s_add_u32 s37, s37, 0
  s_mul_i32 s38, s34, 276480
  s_add_u32 s38, s38, 7340032
  v_lshlrev_b32 v2, 4, v1
  v_add_u32 v3, 4096, v2
  s_cmp_ge_u32 s29, 2
  s_cselect_b32 s39, 2130706432, 0
  v_add_u32 v14, s39, v2
  v_add_u32 v15, s39, v3
  s_waitcnt lgkmcnt(0)
  s_lshl_b32 s40, s35, 12
  s_mul_i32 s41, s35, 5120
  s_add_u32 s40, s40, s37
  s_add_u32 s41, s41, s38
  buffer_load_dwordx4 v[32:35], v2, s[8:11], s41 offen offset:0
  buffer_load_dwordx4 v[16:19], v2, s[8:11], s40 offen offset:0
  buffer_load_dwordx4 v[36:39], v2, s[8:11], s41 offen offset:1024
  buffer_load_dwordx4 v[20:23], v2, s[8:11], s40 offen offset:1024
  buffer_load_dwordx4 v[40:43], v2, s[8:11], s41 offen offset:2048
  buffer_load_dwordx4 v[24:27], v2, s[8:11], s40 offen offset:2048
  buffer_load_dwordx4 v[44:47], v2, s[8:11], s41 offen offset:3072
  buffer_load_dwordx4 v[28:31], v2, s[8:11], s40 offen offset:3072
  buffer_load_dwordx4 v[48:51], v3, s[8:11], s41 offen
  s_add_u32 s35, s35, 4
  s_cmp_ge_u32 s35, 54
  s_cselect_b32 s36, 54, 0
  s_sub_u32 s35, s35, s36
  s_lshl_b32 s40, s35, 12
  s_mul_i32 s41, s35, 5120
  s_add_u32 s40, s40, s37
  s_add_u32 s41, s41, s38
  buffer_load_dwordx4 v[68:71], v2, s[8:11], s41 offen offset:0
  buffer_load_dwordx4 v[52:55], v2, s[8:11], s40 offen offset:0
  buffer_load_dwordx4 v[72:75], v2, s[8:11], s41 offen offset:1024
  buffer_load_dwordx4 v[56:59], v2, s[8:11], s40 offen offset:1024
  buffer_load_dwordx4 v[76:79], v2, s[8:11], s41 offen offset:2048
  buffer_load_dwordx4 v[60:63], v2, s[8:11], s40 offen offset:2048
  buffer_load_dwordx4 v[80:83], v2, s[8:11], s41 offen offset:3072
  buffer_load_dwordx4 v[64:67], v2, s[8:11], s40 offen offset:3072
  buffer_load_dwordx4 v[84:87], v3, s[8:11], s41 offen
  s_add_u32 s35, s35, 4
  s_cmp_ge_u32 s35, 54
  s_cselect_b32 s36, 54, 0
  s_sub_u32 s35, s35, s36
  s_lshl_b32 s40, s35, 12
  s_mul_i32 s41, s35, 5120
  s_add_u32 s40, s40, s37
  s_add_u32 s41, s41, s38
  buffer_load_dwordx4 v[104:107], v2, s[8:11], s41 offen offset:0
  buffer_load_dwordx4 v[88:91], v2, s[8:11], s40 offen offset:0
  buffer_load_dwordx4 v[108:111], v2, s[8:11], s41 offen offset:1024
  buffer_load_dwordx4 v[92:95], v2, s[8:11], s40 offen offset:1024
  buffer_load_dwordx4 v[112:115], v2, s[8:11], s41 offen offset:2048
  buffer_load_dwordx4 v[96:99], v2, s[8:11], s40 offen offset:2048
  buffer_load_dwordx4 v[116:119], v2, s[8:11], s41 offen offset:3072
  buffer_load_dwordx4 v[100:103], v2, s[8:11], s40 offen offset:3072
  buffer_load_dwordx4 v[120:123], v3, s[8:11], s41 offen
  s_add_u32 s35, s35, 4
  s_cmp_ge_u32 s35, 54
  s_cselect_b32 s36, 54, 0
  s_sub_u32 s35, s35, s36
  v_and_b32 v5, 15, v1
  v_lshrrev_b32 v6, 4, v1
  s_lshl_b32 s42, s29, 4
  v_add_u32 v7, s42, v5
  v_mul_u32_u24 v7, 1280, v7
  v_lshl_add_u32 v254, v6, 3, v7
  v_lshlrev_b32 v255, 3, v6
  s_mul_i32 s43, s34, 160
  s_mul_i32 s44, s33, 81920
  s_add_u32 s44, s44, s43
  buffer_load_dwordx2 v[244:245], v254, s[16:19], s44 offen offset:0
  buffer_load_dwordx2 v[246:247], v254, s[16:19], s44 offen offset:32
  buffer_load_dwordx2 v[248:249], v254, s[16:19], s44 offen offset:64
  buffer_load_dwordx2 v[250:251], v254, s[16:19], s44 offen offset:96
  buffer_load_dwordx2 v[252:253], v254, s[16:19], s44 offen offset:128
  buffer_load_dwordx2 v[4:5], v255, s[20:23], s43 offen offset:0
  buffer_load_dwordx2 v[6:7], v255, s[20:23], s43 offen offset:32
  buffer_load_dwordx2 v[8:9], v255, s[20:23], s43 offen offset:64
  buffer_load_dwordx2 v[10:11], v255, s[20:23], s43 offen offset:96
  buffer_load_dwordx2 v[12:13], v255, s[20:23], s43 offen offset:128
  s_lshl_b32 s46, s34, 10
  s_lshl_b32 s47, s30, 7
  s_add_u32 s46, s46, s47
  s_add_u32 s46, s46, 19005440
  s_mov_b32 s47, 0
  s_mul_i32 s45, s29, 15360
  s_mul_i32 s48, s34, 327680
  s_lshl_b32 s49, s33, 7
  s_add_u32 s48, s48, s49
  s_lshl_b32 s49, s29, 5
  s_add_u32 s48, s48, s49
  s_add_u32 s48, s48, 15728640
  s_add_u32 s49, s48, 131072
  s_add_u32 s50, s48, 262144
  s_mul_i32 s51, s29, 3072
  s_add_u32 s51, s51, 61440
  s_waitcnt vmcnt(28)
  v_mfma_f32_16x16x32_bf16 v[124:127], v[32:35], v[16:19], 0
  s_lshl_b32 s40, s35, 12
  s_mul_i32 s41, s35, 5120
  s_add_u32 s40, s40, s37
  s_add_u32 s41, s41, s38
  v_mfma_f32_16x16x32_bf16 v[128:131], v[32:35], v[20:23], 0
  v_mfma_f32_16x16x32_bf16 v[132:135], v[32:35], v[24:27], 0
  buffer_load_dwordx4 v[224:227], v2, s[8:11], s41 offen offset:0
  v_mfma_f32_16x16x32_bf16 v[136:139], v[32:35], v[28:31], 0
  v_mfma_f32_16x16x32_bf16 v[140:143], v[36:39], v[16:19], 0
  buffer_load_dwordx4 v[208:211], v2, s[8:11], s40 offen offset:0
  v_mfma_f32_16x16x32_bf16 v[144:147], v[36:39], v[20:23], 0
  v_mfma_f32_16x16x32_bf16 v[148:151], v[36:39], v[24:27], 0
  buffer_load_dwordx4 v[228:231], v2, s[8:11], s41 offen offset:1024
  v_mfma_f32_16x16x32_bf16 v[152:155], v[36:39], v[28:31], 0
  v_mfma_f32_16x16x32_bf16 v[156:159], v[40:43], v[16:19], 0
  buffer_load_dwordx4 v[212:215], v2, s[8:11], s40 offen offset:1024
  v_mfma_f32_16x16x32_bf16 v[160:163], v[40:43], v[20:23], 0
  v_mfma_f32_16x16x32_bf16 v[164:167], v[40:43], v[24:27], 0
  buffer_load_dwordx4 v[232:235], v2, s[8:11], s41 offen offset:2048
  v_mfma_f32_16x16x32_bf16 v[168:171], v[40:43], v[28:31], 0
  v_mfma_f32_16x16x32_bf16 v[172:175], v[44:47], v[16:19], 0
  buffer_load_dwordx4 v[216:219], v2, s[8:11], s40 offen offset:2048
  v_mfma_f32_16x16x32_bf16 v[176:179], v[44:47], v[20:23], 0
  v_mfma_f32_16x16x32_bf16 v[180:183], v[44:47], v[24:27], 0
  buffer_load_dwordx4 v[236:239], v2, s[8:11], s41 offen offset:3072
  v_mfma_f32_16x16x32_bf16 v[184:187], v[44:47], v[28:31], 0
  v_mfma_f32_16x16x32_bf16 v[188:191], v[48:51], v[16:19], 0
  buffer_load_dwordx4 v[220:223], v2, s[8:11], s40 offen offset:3072
  v_mfma_f32_16x16x32_bf16 v[192:195], v[48:51], v[20:23], 0
  v_mfma_f32_16x16x32_bf16 v[196:199], v[48:51], v[24:27], 0
  buffer_load_dwordx4 v[240:243], v3, s[8:11], s41 offen
  v_mfma_f32_16x16x32_bf16 v[200:203], v[48:51], v[28:31], 0
  s_add_u32 s35, s35, 4
  s_cmp_ge_u32 s35, 54
  s_cselect_b32 s36, 54, 0
  s_sub_u32 s35, s35, s36
  s_waitcnt vmcnt(28)
  v_mfma_f32_16x16x32_bf16 v[124:127], v[68:71], v[52:55], v[124:127]
  s_lshl_b32 s40, s35, 12
  s_mul_i32 s41, s35, 5120
  s_add_u32 s40, s40, s37
  s_add_u32 s41, s41, s38
  v_mfma_f32_16x16x32_bf16 v[128:131], v[68:71], v[56:59], v[128:131]
  v_mfma_f32_16x16x32_bf16 v[132:135], v[68:71], v[60:63], v[132:135]
  buffer_load_dwordx4 v[32:35], v2, s[8:11], s41 offen offset:0
  v_mfma_f32_16x16x32_bf16 v[136:139], v[68:71], v[64:67], v[136:139]
  v_mfma_f32_16x16x32_bf16 v[140:143], v[72:75], v[52:55], v[140:143]
  buffer_load_dwordx4 v[16:19], v2, s[8:11], s40 offen offset:0
  v_mfma_f32_16x16x32_bf16 v[144:147], v[72:75], v[56:59], v[144:147]
  v_mfma_f32_16x16x32_bf16 v[148:151], v[72:75], v[60:63], v[148:151]
  buffer_load_dwordx4 v[36:39], v2, s[8:11], s41 offen offset:1024
  v_mfma_f32_16x16x32_bf16 v[152:155], v[72:75], v[64:67], v[152:155]
  v_mfma_f32_16x16x32_bf16 v[156:159], v[76:79], v[52:55], v[156:159]
  buffer_load_dwordx4 v[20:23], v2, s[8:11], s40 offen offset:1024
  v_mfma_f32_16x16x32_bf16 v[160:163], v[76:79], v[56:59], v[160:163]
  v_mfma_f32_16x16x32_bf16 v[164:167], v[76:79], v[60:63], v[164:167]
  buffer_load_dwordx4 v[40:43], v2, s[8:11], s41 offen offset:2048
  v_mfma_f32_16x16x32_bf16 v[168:171], v[76:79], v[64:67], v[168:171]
  v_mfma_f32_16x16x32_bf16 v[172:175], v[80:83], v[52:55], v[172:175]
  buffer_load_dwordx4 v[24:27], v2, s[8:11], s40 offen offset:2048
  v_mfma_f32_16x16x32_bf16 v[176:179], v[80:83], v[56:59], v[176:179]
  v_mfma_f32_16x16x32_bf16 v[180:183], v[80:83], v[60:63], v[180:183]
  buffer_load_dwordx4 v[44:47], v2, s[8:11], s41 offen offset:3072
  v_mfma_f32_16x16x32_bf16 v[184:187], v[80:83], v[64:67], v[184:187]
  v_mfma_f32_16x16x32_bf16 v[188:191], v[84:87], v[52:55], v[188:191]
  buffer_load_dwordx4 v[28:31], v2, s[8:11], s40 offen offset:3072
  v_mfma_f32_16x16x32_bf16 v[192:195], v[84:87], v[56:59], v[192:195]
  v_mfma_f32_16x16x32_bf16 v[196:199], v[84:87], v[60:63], v[196:199]
  buffer_load_dwordx4 v[48:51], v3, s[8:11], s41 offen
  v_mfma_f32_16x16x32_bf16 v[200:203], v[84:87], v[64:67], v[200:203]
  s_add_u32 s35, s35, 4
  s_cmp_ge_u32 s35, 54
  s_cselect_b32 s36, 54, 0
  s_sub_u32 s35, s35, s36
  s_waitcnt vmcnt(28)
  v_mfma_f32_16x16x32_bf16 v[124:127], v[104:107], v[88:91], v[124:127]
  s_lshl_b32 s40, s35, 12
  s_mul_i32 s41, s35, 5120
  s_add_u32 s40, s40, s37
  s_add_u32 s41, s41, s38
  v_mfma_f32_16x16x32_bf16 v[128:131], v[104:107], v[92:95], v[128:131]
  v_mfma_f32_16x16x32_bf16 v[132:135], v[104:107], v[96:99], v[132:135]
  buffer_load_dwordx4 v[68:71], v2, s[8:11], s41 offen offset:0
  v_mfma_f32_16x16x32_bf16 v[136:139], v[104:107], v[100:103], v[136:139]
  v_mfma_f32_16x16x32_bf16 v[140:143], v[108:111], v[88:91], v[140:143]
  buffer_load_dwordx4 v[52:55], v2, s[8:11], s40 offen offset:0
  v_mfma_f32_16x16x32_bf16 v[144:147], v[108:111], v[92:95], v[144:147]
  v_mfma_f32_16x16x32_bf16 v[148:151], v[108:111], v[96:99], v[148:151]
  buffer_load_dwordx4 v[72:75], v2, s[8:11], s41 offen offset:1024
  v_mfma_f32_16x16x32_bf16 v[152:155], v[108:111], v[100:103], v[152:155]
  v_mfma_f32_16x16x32_bf16 v[156:159], v[112:115], v[88:91], v[156:159]
  buffer_load_dwordx4 v[56:59], v2, s[8:11], s40 offen offset:1024
  v_mfma_f32_16x16x32_bf16 v[160:163], v[112:115], v[92:95], v[160:163]
  v_mfma_f32_16x16x32_bf16 v[164:167], v[112:115], v[96:99], v[164:167]
  buffer_load_dwordx4 v[76:79], v2, s[8:11], s41 offen offset:2048
  v_mfma_f32_16x16x32_bf16 v[168:171], v[112:115], v[100:103], v[168:171]
  v_mfma_f32_16x16x32_bf16 v[172:175], v[116:119], v[88:91], v[172:175]
  buffer_load_dwordx4 v[60:63], v2, s[8:11], s40 offen offset:2048
  v_mfma_f32_16x16x32_bf16 v[176:179], v[116:119], v[92:95], v[176:179]
  v_mfma_f32_16x16x32_bf16 v[180:183], v[116:119], v[96:99], v[180:183]
  buffer_load_dwordx4 v[80:83], v2, s[8:11], s41 offen offset:3072
  v_mfma_f32_16x16x32_bf16 v[184:187], v[116:119], v[100:103], v[184:187]
  v_mfma_f32_16x16x32_bf16 v[188:191], v[120:123], v[88:91], v[188:191]
  buffer_load_dwordx4 v[64:67], v2, s[8:11], s40 offen offset:3072
  v_mfma_f32_16x16x32_bf16 v[192:195], v[120:123], v[92:95], v[192:195]
  v_mfma_f32_16x16x32_bf16 v[196:199], v[120:123], v[96:99], v[196:199]
  buffer_load_dwordx4 v[84:87], v3, s[8:11], s41 offen
  v_mfma_f32_16x16x32_bf16 v[200:203], v[120:123], v[100:103], v[200:203]
  s_add_u32 s35, s35, 4
  s_cmp_ge_u32 s35, 54
  s_cselect_b32 s36, 54, 0
  s_sub_u32 s35, s35, s36
  s_waitcnt vmcnt(18)
  v_mfma_f32_16x16x32_bf16 v[124:127], v[224:227], v[208:211], v[124:127]
  s_lshl_b32 s40, s35, 12
  s_mul_i32 s41, s35, 5120
  s_add_u32 s40, s40, s37
  s_add_u32 s41, s41, s38
  v_mfma_f32_16x16x32_bf16 v[128:131], v[224:227], v[212:215], v[128:131]
  v_mfma_f32_16x16x32_bf16 v[132:135], v[224:227], v[216:219], v[132:135]
  buffer_load_dwordx4 v[104:107], v2, s[8:11], s41 offen offset:0
  v_mfma_f32_16x16x32_bf16 v[136:139], v[224:227], v[220:223], v[136:139]
  v_mfma_f32_16x16x32_bf16 v[140:143], v[228:231], v[208:211], v[140:143]
  buffer_load_dwordx4 v[88:91], v2, s[8:11], s40 offen offset:0
  v_mfma_f32_16x16x32_bf16 v[144:147], v[228:231], v[212:215], v[144:147]
  v_mfma_f32_16x16x32_bf16 v[148:151], v[228:231], v[216:219], v[148:151]
  buffer_load_dwordx4 v[108:111], v2, s[8:11], s41 offen offset:1024
  v_mfma_f32_16x16x32_bf16 v[152:155], v[228:231], v[220:223], v[152:155]
  v_mfma_f32_16x16x32_bf16 v[156:159], v[232:235], v[208:211], v[156:159]
  buffer_load_dwordx4 v[92:95], v2, s[8:11], s40 offen offset:1024
  v_mfma_f32_16x16x32_bf16 v[160:163], v[232:235], v[212:215], v[160:163]
  v_mfma_f32_16x16x32_bf16 v[164:167], v[232:235], v[216:219], v[164:167]
  buffer_load_dwordx4 v[112:115], v2, s[8:11], s41 offen offset:2048
  v_mfma_f32_16x16x32_bf16 v[168:171], v[232:235], v[220:223], v[168:171]
  v_mfma_f32_16x16x32_bf16 v[172:175], v[236:239], v[208:211], v[172:175]
  buffer_load_dwordx4 v[96:99], v2, s[8:11], s40 offen offset:2048
  v_mfma_f32_16x16x32_bf16 v[176:179], v[236:239], v[212:215], v[176:179]
  v_mfma_f32_16x16x32_bf16 v[180:183], v[236:239], v[216:219], v[180:183]
  buffer_load_dwordx4 v[116:119], v2, s[8:11], s41 offen offset:3072
  v_mfma_f32_16x16x32_bf16 v[184:187], v[236:239], v[220:223], v[184:187]
  v_mfma_f32_16x16x32_bf16 v[188:191], v[240:243], v[208:211], v[188:191]
  buffer_load_dwordx4 v[100:103], v2, s[8:11], s40 offen offset:3072
  v_mfma_f32_16x16x32_bf16 v[192:195], v[240:243], v[212:215], v[192:195]
  v_mfma_f32_16x16x32_bf16 v[196:199], v[240:243], v[216:219], v[196:199]
  buffer_load_dwordx4 v[120:123], v3, s[8:11], s41 offen
  v_mfma_f32_16x16x32_bf16 v[200:203], v[240:243], v[220:223], v[200:203]
  s_add_u32 s35, s35, 4
  s_cmp_ge_u32 s35, 54
  s_cselect_b32 s36, 54, 0
  s_sub_u32 s35, s35, s36
  s_waitcnt vmcnt(18)
  v_mfma_f32_16x16x32_bf16 v[124:127], v[32:35], v[16:19], v[124:127]
  s_lshl_b32 s40, s35, 12
  s_mul_i32 s41, s35, 5120
  s_add_u32 s40, s40, s37
  s_add_u32 s41, s41, s38
  v_mfma_f32_16x16x32_bf16 v[128:131], v[32:35], v[20:23], v[128:131]
  v_mfma_f32_16x16x32_bf16 v[132:135], v[32:35], v[24:27], v[132:135]
  buffer_load_dwordx4 v[224:227], v2, s[8:11], s41 offen offset:0
  v_mfma_f32_16x16x32_bf16 v[136:139], v[32:35], v[28:31], v[136:139]
  v_mfma_f32_16x16x32_bf16 v[140:143], v[36:39], v[16:19], v[140:143]
  buffer_load_dwordx4 v[208:211], v2, s[8:11], s40 offen offset:0
  v_mfma_f32_16x16x32_bf16 v[144:147], v[36:39], v[20:23], v[144:147]
  v_mfma_f32_16x16x32_bf16 v[148:151], v[36:39], v[24:27], v[148:151]
  buffer_load_dwordx4 v[228:231], v2, s[8:11], s41 offen offset:1024
  v_mfma_f32_16x16x32_bf16 v[152:155], v[36:39], v[28:31], v[152:155]
  v_mfma_f32_16x16x32_bf16 v[156:159], v[40:43], v[16:19], v[156:159]
  buffer_load_dwordx4 v[212:215], v2, s[8:11], s40 offen offset:1024
  v_mfma_f32_16x16x32_bf16 v[160:163], v[40:43], v[20:23], v[160:163]
  v_mfma_f32_16x16x32_bf16 v[164:167], v[40:43], v[24:27], v[164:167]
  buffer_load_dwordx4 v[232:235], v2, s[8:11], s41 offen offset:2048
  v_mfma_f32_16x16x32_bf16 v[168:171], v[40:43], v[28:31], v[168:171]
  v_mfma_f32_16x16x32_bf16 v[172:175], v[44:47], v[16:19], v[172:175]
  buffer_load_dwordx4 v[216:219], v2, s[8:11], s40 offen offset:2048
  v_mfma_f32_16x16x32_bf16 v[176:179], v[44:47], v[20:23], v[176:179]
  v_mfma_f32_16x16x32_bf16 v[180:183], v[44:47], v[24:27], v[180:183]
  buffer_load_dwordx4 v[236:239], v2, s[8:11], s41 offen offset:3072
  v_mfma_f32_16x16x32_bf16 v[184:187], v[44:47], v[28:31], v[184:187]
  v_mfma_f32_16x16x32_bf16 v[188:191], v[48:51], v[16:19], v[188:191]
  buffer_load_dwordx4 v[220:223], v2, s[8:11], s40 offen offset:3072
  v_mfma_f32_16x16x32_bf16 v[192:195], v[48:51], v[20:23], v[192:195]
  v_mfma_f32_16x16x32_bf16 v[196:199], v[48:51], v[24:27], v[196:199]
  buffer_load_dwordx4 v[240:243], v3, s[8:11], s41 offen
  v_mfma_f32_16x16x32_bf16 v[200:203], v[48:51], v[28:31], v[200:203]
  s_add_u32 s35, s35, 4
  s_cmp_ge_u32 s35, 54
  s_cselect_b32 s36, 54, 0
  s_sub_u32 s35, s35, s36
  s_waitcnt vmcnt(18)
  v_mfma_f32_16x16x32_bf16 v[124:127], v[68:71], v[52:55], v[124:127]
  s_lshl_b32 s40, s35, 12
  s_mul_i32 s41, s35, 5120
  s_add_u32 s40, s40, s37
  s_add_u32 s41, s41, s38
  v_mfma_f32_16x16x32_bf16 v[128:131], v[68:71], v[56:59], v[128:131]
  v_mfma_f32_16x16x32_bf16 v[132:135], v[68:71], v[60:63], v[132:135]
  buffer_load_dwordx4 v[32:35], v2, s[8:11], s41 offen offset:0
  v_mfma_f32_16x16x32_bf16 v[136:139], v[68:71], v[64:67], v[136:139]
  v_mfma_f32_16x16x32_bf16 v[140:143], v[72:75], v[52:55], v[140:143]
  buffer_load_dwordx4 v[16:19], v2, s[8:11], s40 offen offset:0
  v_mfma_f32_16x16x32_bf16 v[144:147], v[72:75], v[56:59], v[144:147]
  v_mfma_f32_16x16x32_bf16 v[148:151], v[72:75], v[60:63], v[148:151]
  buffer_load_dwordx4 v[36:39], v2, s[8:11], s41 offen offset:1024
  v_mfma_f32_16x16x32_bf16 v[152:155], v[72:75], v[64:67], v[152:155]
  v_mfma_f32_16x16x32_bf16 v[156:159], v[76:79], v[52:55], v[156:159]
  buffer_load_dwordx4 v[20:23], v2, s[8:11], s40 offen offset:1024
  v_mfma_f32_16x16x32_bf16 v[160:163], v[76:79], v[56:59], v[160:163]
  v_mfma_f32_16x16x32_bf16 v[164:167], v[76:79], v[60:63], v[164:167]
  buffer_load_dwordx4 v[40:43], v2, s[8:11], s41 offen offset:2048
  v_mfma_f32_16x16x32_bf16 v[168:171], v[76:79], v[64:67], v[168:171]
  v_mfma_f32_16x16x32_bf16 v[172:175], v[80:83], v[52:55], v[172:175]
  buffer_load_dwordx4 v[24:27], v2, s[8:11], s40 offen offset:2048
  v_mfma_f32_16x16x32_bf16 v[176:179], v[80:83], v[56:59], v[176:179]
  v_mfma_f32_16x16x32_bf16 v[180:183], v[80:83], v[60:63], v[180:183]
  buffer_load_dwordx4 v[44:47], v2, s[8:11], s41 offen offset:3072
  v_mfma_f32_16x16x32_bf16 v[184:187], v[80:83], v[64:67], v[184:187]
  v_mfma_f32_16x16x32_bf16 v[188:191], v[84:87], v[52:55], v[188:191]
  buffer_load_dwordx4 v[28:31], v2, s[8:11], s40 offen offset:3072
  v_mfma_f32_16x16x32_bf16 v[192:195], v[84:87], v[56:59], v[192:195]
  v_mfma_f32_16x16x32_bf16 v[196:199], v[84:87], v[60:63], v[196:199]
  buffer_load_dwordx4 v[48:51], v3, s[8:11], s41 offen
  v_mfma_f32_16x16x32_bf16 v[200:203], v[84:87], v[64:67], v[200:203]
  s_add_u32 s35, s35, 4
  s_cmp_ge_u32 s35, 54
  s_cselect_b32 s36, 54, 0
  s_sub_u32 s35, s35, s36
  s_waitcnt vmcnt(18)
  v_mfma_f32_16x16x32_bf16 v[124:127], v[104:107], v[88:91], v[124:127]
  s_lshl_b32 s40, s35, 12
  s_mul_i32 s41, s35, 5120
  s_add_u32 s40, s40, s37
  s_add_u32 s41, s41, s38
  v_mfma_f32_16x16x32_bf16 v[128:131], v[104:107], v[92:95], v[128:131]
  v_mfma_f32_16x16x32_bf16 v[132:135], v[104:107], v[96:99], v[132:135]
  buffer_load_dwordx4 v[68:71], v2, s[8:11], s41 offen offset:0
  v_mfma_f32_16x16x32_bf16 v[136:139], v[104:107], v[100:103], v[136:139]
  v_mfma_f32_16x16x32_bf16 v[140:143], v[108:111], v[88:91], v[140:143]
  buffer_load_dwordx4 v[52:55], v2, s[8:11], s40 offen offset:0
  v_mfma_f32_16x16x32_bf16 v[144:147], v[108:111], v[92:95], v[144:147]
  v_mfma_f32_16x16x32_bf16 v[148:151], v[108:111], v[96:99], v[148:151]
  buffer_load_dwordx4 v[72:75], v2, s[8:11], s41 offen offset:1024
  v_mfma_f32_16x16x32_bf16 v[152:155], v[108:111], v[100:103], v[152:155]
  v_mfma_f32_16x16x32_bf16 v[156:159], v[112:115], v[88:91], v[156:159]
  buffer_load_dwordx4 v[56:59], v2, s[8:11], s40 offen offset:1024
  v_mfma_f32_16x16x32_bf16 v[160:163], v[112:115], v[92:95], v[160:163]
  v_mfma_f32_16x16x32_bf16 v[164:167], v[112:115], v[96:99], v[164:167]
  buffer_load_dwordx4 v[76:79], v2, s[8:11], s41 offen offset:2048
  v_mfma_f32_16x16x32_bf16 v[168:171], v[112:115], v[100:103], v[168:171]
  v_mfma_f32_16x16x32_bf16 v[172:175], v[116:119], v[88:91], v[172:175]
  buffer_load_dwordx4 v[60:63], v2, s[8:11], s40 offen offset:2048
  v_mfma_f32_16x16x32_bf16 v[176:179], v[116:119], v[92:95], v[176:179]
  v_mfma_f32_16x16x32_bf16 v[180:183], v[116:119], v[96:99], v[180:183]
  buffer_load_dwordx4 v[80:83], v2, s[8:11], s41 offen offset:3072
  v_mfma_f32_16x16x32_bf16 v[184:187], v[116:119], v[100:103], v[184:187]
  v_mfma_f32_16x16x32_bf16 v[188:191], v[120:123], v[88:91], v[188:191]
  buffer_load_dwordx4 v[64:67], v2, s[8:11], s40 offen offset:3072
  v_mfma_f32_16x16x32_bf16 v[192:195], v[120:123], v[92:95], v[192:195]
  v_mfma_f32_16x16x32_bf16 v[196:199], v[120:123], v[96:99], v[196:199]
  buffer_load_dwordx4 v[84:87], v3, s[8:11], s41 offen
  v_mfma_f32_16x16x32_bf16 v[200:203], v[120:123], v[100:103], v[200:203]
  s_add_u32 s35, s35, 4
  s_cmp_ge_u32 s35, 54
  s_cselect_b32 s36, 54, 0
  s_sub_u32 s35, s35, s36
  s_waitcnt vmcnt(18)
  v_mfma_f32_16x16x32_bf16 v[124:127], v[224:227], v[208:211], v[124:127]
  s_lshl_b32 s40, s35, 12
  s_mul_i32 s41, s35, 5120
  s_add_u32 s40, s40, s37
  s_add_u32 s41, s41, s38
  v_mfma_f32_16x16x32_bf16 v[128:131], v[224:227], v[212:215], v[128:131]
  v_mfma_f32_16x16x32_bf16 v[132:135], v[224:227], v[216:219], v[132:135]
  buffer_load_dwordx4 v[104:107], v2, s[8:11], s41 offen offset:0
  v_mfma_f32_16x16x32_bf16 v[136:139], v[224:227], v[220:223], v[136:139]
  v_mfma_f32_16x16x32_bf16 v[140:143], v[228:231], v[208:211], v[140:143]
  buffer_load_dwordx4 v[88:91], v2, s[8:11], s40 offen offset:0
  v_mfma_f32_16x16x32_bf16 v[144:147], v[228:231], v[212:215], v[144:147]
  v_mfma_f32_16x16x32_bf16 v[148:151], v[228:231], v[216:219], v[148:151]
  buffer_load_dwordx4 v[108:111], v2, s[8:11], s41 offen offset:1024
  v_mfma_f32_16x16x32_bf16 v[152:155], v[228:231], v[220:223], v[152:155]
  v_mfma_f32_16x16x32_bf16 v[156:159], v[232:235], v[208:211], v[156:159]
  buffer_load_dwordx4 v[92:95], v2, s[8:11], s40 offen offset:1024
  v_mfma_f32_16x16x32_bf16 v[160:163], v[232:235], v[212:215], v[160:163]
  v_mfma_f32_16x16x32_bf16 v[164:167], v[232:235], v[216:219], v[164:167]
  buffer_load_dwordx4 v[112:115], v2, s[8:11], s41 offen offset:2048
  v_mfma_f32_16x16x32_bf16 v[168:171], v[232:235], v[220:223], v[168:171]
  v_mfma_f32_16x16x32_bf16 v[172:175], v[236:239], v[208:211], v[172:175]
  buffer_load_dwordx4 v[96:99], v2, s[8:11], s40 offen offset:2048
  v_mfma_f32_16x16x32_bf16 v[176:179], v[236:239], v[212:215], v[176:179]
  v_mfma_f32_16x16x32_bf16 v[180:183], v[236:239], v[216:219], v[180:183]
  buffer_load_dwordx4 v[116:119], v2, s[8:11], s41 offen offset:3072
  v_mfma_f32_16x16x32_bf16 v[184:187], v[236:239], v[220:223], v[184:187]
  v_mfma_f32_16x16x32_bf16 v[188:191], v[240:243], v[208:211], v[188:191]
  buffer_load_dwordx4 v[100:103], v2, s[8:11], s40 offen offset:3072
  v_mfma_f32_16x16x32_bf16 v[192:195], v[240:243], v[212:215], v[192:195]
  v_mfma_f32_16x16x32_bf16 v[196:199], v[240:243], v[216:219], v[196:199]
  buffer_load_dwordx4 v[120:123], v3, s[8:11], s41 offen
  v_mfma_f32_16x16x32_bf16 v[200:203], v[240:243], v[220:223], v[200:203]
  s_add_u32 s35, s35, 4
  s_cmp_ge_u32 s35, 54
  s_cselect_b32 s36, 54, 0
  s_sub_u32 s35, s35, s36
  s_waitcnt vmcnt(18)
  v_mfma_f32_16x16x32_bf16 v[124:127], v[32:35], v[16:19], v[124:127]
  s_lshl_b32 s40, s35, 12
  s_mul_i32 s41, s35, 5120
  s_add_u32 s40, s40, s37
  s_add_u32 s41, s41, s38
  v_mfma_f32_16x16x32_bf16 v[128:131], v[32:35], v[20:23], v[128:131]
  v_mfma_f32_16x16x32_bf16 v[132:135], v[32:35], v[24:27], v[132:135]
  buffer_load_dwordx4 v[224:227], v2, s[8:11], s41 offen offset:0
  v_mfma_f32_16x16x32_bf16 v[136:139], v[32:35], v[28:31], v[136:139]
  v_mfma_f32_16x16x32_bf16 v[140:143], v[36:39], v[16:19], v[140:143]
  buffer_load_dwordx4 v[208:211], v2, s[8:11], s40 offen offset:0
  v_mfma_f32_16x16x32_bf16 v[144:147], v[36:39], v[20:23], v[144:147]
  v_mfma_f32_16x16x32_bf16 v[148:151], v[36:39], v[24:27], v[148:151]
  buffer_load_dwordx4 v[228:231], v2, s[8:11], s41 offen offset:1024
  v_mfma_f32_16x16x32_bf16 v[152:155], v[36:39], v[28:31], v[152:155]
  v_mfma_f32_16x16x32_bf16 v[156:159], v[40:43], v[16:19], v[156:159]
  buffer_load_dwordx4 v[212:215], v2, s[8:11], s40 offen offset:1024
  v_mfma_f32_16x16x32_bf16 v[160:163], v[40:43], v[20:23], v[160:163]
  v_mfma_f32_16x16x32_bf16 v[164:167], v[40:43], v[24:27], v[164:167]
  buffer_load_dwordx4 v[232:235], v2, s[8:11], s41 offen offset:2048
  v_mfma_f32_16x16x32_bf16 v[168:171], v[40:43], v[28:31], v[168:171]
  v_mfma_f32_16x16x32_bf16 v[172:175], v[44:47], v[16:19], v[172:175]
  buffer_load_dwordx4 v[216:219], v2, s[8:11], s40 offen offset:2048
  v_mfma_f32_16x16x32_bf16 v[176:179], v[44:47], v[20:23], v[176:179]
  v_mfma_f32_16x16x32_bf16 v[180:183], v[44:47], v[24:27], v[180:183]
  buffer_load_dwordx4 v[236:239], v2, s[8:11], s41 offen offset:3072
  v_mfma_f32_16x16x32_bf16 v[184:187], v[44:47], v[28:31], v[184:187]
  v_mfma_f32_16x16x32_bf16 v[188:191], v[48:51], v[16:19], v[188:191]
  buffer_load_dwordx4 v[220:223], v2, s[8:11], s40 offen offset:3072
  v_mfma_f32_16x16x32_bf16 v[192:195], v[48:51], v[20:23], v[192:195]
  v_mfma_f32_16x16x32_bf16 v[196:199], v[48:51], v[24:27], v[196:199]
  buffer_load_dwordx4 v[240:243], v3, s[8:11], s41 offen
  v_mfma_f32_16x16x32_bf16 v[200:203], v[48:51], v[28:31], v[200:203]
  s_add_u32 s35, s35, 4
  s_cmp_ge_u32 s35, 54
  s_cselect_b32 s36, 54, 0
  s_sub_u32 s35, s35, s36
  s_waitcnt vmcnt(18)
  v_mfma_f32_16x16x32_bf16 v[124:127], v[68:71], v[52:55], v[124:127]
  s_lshl_b32 s40, s35, 12
  s_mul_i32 s41, s35, 5120
  s_add_u32 s40, s40, s37
  s_add_u32 s41, s41, s38
  v_mfma_f32_16x16x32_bf16 v[128:131], v[68:71], v[56:59], v[128:131]
  v_mfma_f32_16x16x32_bf16 v[132:135], v[68:71], v[60:63], v[132:135]
  buffer_load_dwordx4 v[32:35], v2, s[8:11], s41 offen offset:0
  v_mfma_f32_16x16x32_bf16 v[136:139], v[68:71], v[64:67], v[136:139]
  v_mfma_f32_16x16x32_bf16 v[140:143], v[72:75], v[52:55], v[140:143]
  buffer_load_dwordx4 v[16:19], v2, s[8:11], s40 offen offset:0
  v_mfma_f32_16x16x32_bf16 v[144:147], v[72:75], v[56:59], v[144:147]
  v_mfma_f32_16x16x32_bf16 v[148:151], v[72:75], v[60:63], v[148:151]
  buffer_load_dwordx4 v[36:39], v2, s[8:11], s41 offen offset:1024
  v_mfma_f32_16x16x32_bf16 v[152:155], v[72:75], v[64:67], v[152:155]
  v_mfma_f32_16x16x32_bf16 v[156:159], v[76:79], v[52:55], v[156:159]
  buffer_load_dwordx4 v[20:23], v2, s[8:11], s40 offen offset:1024
  v_mfma_f32_16x16x32_bf16 v[160:163], v[76:79], v[56:59], v[160:163]
  v_mfma_f32_16x16x32_bf16 v[164:167], v[76:79], v[60:63], v[164:167]
  buffer_load_dwordx4 v[40:43], v2, s[8:11], s41 offen offset:2048
  v_mfma_f32_16x16x32_bf16 v[168:171], v[76:79], v[64:67], v[168:171]
  v_mfma_f32_16x16x32_bf16 v[172:175], v[80:83], v[52:55], v[172:175]
  buffer_load_dwordx4 v[24:27], v2, s[8:11], s40 offen offset:2048
  v_mfma_f32_16x16x32_bf16 v[176:179], v[80:83], v[56:59], v[176:179]
  v_mfma_f32_16x16x32_bf16 v[180:183], v[80:83], v[60:63], v[180:183]
  buffer_load_dwordx4 v[44:47], v2, s[8:11], s41 offen offset:3072
  v_mfma_f32_16x16x32_bf16 v[184:187], v[80:83], v[64:67], v[184:187]
  v_mfma_f32_16x16x32_bf16 v[188:191], v[84:87], v[52:55], v[188:191]
  buffer_load_dwordx4 v[28:31], v2, s[8:11], s40 offen offset:3072
  v_mfma_f32_16x16x32_bf16 v[192:195], v[84:87], v[56:59], v[192:195]
  v_mfma_f32_16x16x32_bf16 v[196:199], v[84:87], v[60:63], v[196:199]
  buffer_load_dwordx4 v[48:51], v3, s[8:11], s41 offen
  v_mfma_f32_16x16x32_bf16 v[200:203], v[84:87], v[64:67], v[200:203]
  s_add_u32 s35, s35, 4
  s_cmp_ge_u32 s35, 54
  s_cselect_b32 s36, 54, 0
  s_sub_u32 s35, s35, s36
  s_waitcnt vmcnt(18)
  v_mfma_f32_16x16x32_bf16 v[124:127], v[104:107], v[88:91], v[124:127]
  s_lshl_b32 s40, s35, 12
  s_mul_i32 s41, s35, 5120
  s_add_u32 s40, s40, s37
  s_add_u32 s41, s41, s38
  v_mfma_f32_16x16x32_bf16 v[128:131], v[104:107], v[92:95], v[128:131]
  v_mfma_f32_16x16x32_bf16 v[132:135], v[104:107], v[96:99], v[132:135]
  buffer_load_dwordx4 v[68:71], v14, s[8:11], s41 offen offset:0
  v_mfma_f32_16x16x32_bf16 v[136:139], v[104:107], v[100:103], v[136:139]
  v_mfma_f32_16x16x32_bf16 v[140:143], v[108:111], v[88:91], v[140:143]
  buffer_load_dwordx4 v[52:55], v14, s[8:11], s40 offen offset:0
  v_mfma_f32_16x16x32_bf16 v[144:147], v[108:111], v[92:95], v[144:147]
  v_mfma_f32_16x16x32_bf16 v[148:151], v[108:111], v[96:99], v[148:151]
  buffer_load_dwordx4 v[72:75], v14, s[8:11], s41 offen offset:1024
  v_mfma_f32_16x16x32_bf16 v[152:155], v[108:111], v[100:103], v[152:155]
  v_mfma_f32_16x16x32_bf16 v[156:159], v[112:115], v[88:91], v[156:159]
  buffer_load_dwordx4 v[56:59], v14, s[8:11], s40 offen offset:1024
  v_mfma_f32_16x16x32_bf16 v[160:163], v[112:115], v[92:95], v[160:163]
  v_mfma_f32_16x16x32_bf16 v[164:167], v[112:115], v[96:99], v[164:167]
  buffer_load_dwordx4 v[76:79], v14, s[8:11], s41 offen offset:2048
  v_mfma_f32_16x16x32_bf16 v[168:171], v[112:115], v[100:103], v[168:171]
  v_mfma_f32_16x16x32_bf16 v[172:175], v[116:119], v[88:91], v[172:175]
  buffer_load_dwordx4 v[60:63], v14, s[8:11], s40 offen offset:2048
  v_mfma_f32_16x16x32_bf16 v[176:179], v[116:119], v[92:95], v[176:179]
  v_mfma_f32_16x16x32_bf16 v[180:183], v[116:119], v[96:99], v[180:183]
  buffer_load_dwordx4 v[80:83], v14, s[8:11], s41 offen offset:3072
  v_mfma_f32_16x16x32_bf16 v[184:187], v[116:119], v[100:103], v[184:187]
  v_mfma_f32_16x16x32_bf16 v[188:191], v[120:123], v[88:91], v[188:191]
  buffer_load_dwordx4 v[64:67], v14, s[8:11], s40 offen offset:3072
  v_mfma_f32_16x16x32_bf16 v[192:195], v[120:123], v[92:95], v[192:195]
  v_mfma_f32_16x16x32_bf16 v[196:199], v[120:123], v[96:99], v[196:199]
  buffer_load_dwordx4 v[84:87], v15, s[8:11], s41 offen
  v_mfma_f32_16x16x32_bf16 v[200:203], v[120:123], v[100:103], v[200:203]
  s_add_u32 s35, s35, 4
  s_cmp_ge_u32 s35, 54
  s_cselect_b32 s36, 54, 0
  s_sub_u32 s35, s35, s36
  s_waitcnt vmcnt(18)
  v_mfma_f32_16x16x32_bf16 v[124:127], v[224:227], v[208:211], v[124:127]
  v_mfma_f32_16x16x32_bf16 v[128:131], v[224:227], v[212:215], v[128:131]
  v_mfma_f32_16x16x32_bf16 v[132:135], v[224:227], v[216:219], v[132:135]
  v_mfma_f32_16x16x32_bf16 v[136:139], v[224:227], v[220:223], v[136:139]
  v_mfma_f32_16x16x32_bf16 v[140:143], v[228:231], v[208:211], v[140:143]
  v_mfma_f32_16x16x32_bf16 v[144:147], v[228:231], v[212:215], v[144:147]
  v_mfma_f32_16x16x32_bf16 v[148:151], v[228:231], v[216:219], v[148:151]
  v_mfma_f32_16x16x32_bf16 v[152:155], v[228:231], v[220:223], v[152:155]
  v_mfma_f32_16x16x32_bf16 v[156:159], v[232:235], v[208:211], v[156:159]
  v_mfma_f32_16x16x32_bf16 v[160:163], v[232:235], v[212:215], v[160:163]
  v_mfma_f32_16x16x32_bf16 v[164:167], v[232:235], v[216:219], v[164:167]
  v_mfma_f32_16x16x32_bf16 v[168:171], v[232:235], v[220:223], v[168:171]
  v_mfma_f32_16x16x32_bf16 v[172:175], v[236:239], v[208:211], v[172:175]
  v_mfma_f32_16x16x32_bf16 v[176:179], v[236:239], v[212:215], v[176:179]
  v_mfma_f32_16x16x32_bf16 v[180:183], v[236:239], v[216:219], v[180:183]
  v_mfma_f32_16x16x32_bf16 v[184:187], v[236:239], v[220:223], v[184:187]
  v_mfma_f32_16x16x32_bf16 v[188:191], v[240:243], v[208:211], v[188:191]
  v_mfma_f32_16x16x32_bf16 v[192:195], v[240:243], v[212:215], v[192:195]
  v_mfma_f32_16x16x32_bf16 v[196:199], v[240:243], v[216:219], v[196:199]
  v_mfma_f32_16x16x32_bf16 v[200:203], v[240:243], v[220:223], v[200:203]
  buffer_load_dword v3, off, s[8:11], s46 sc1
  s_waitcnt vmcnt(10)
  v_mfma_f32_16x16x32_bf16 v[124:127], v[32:35], v[16:19], v[124:127]
  v_mfma_f32_16x16x32_bf16 v[128:131], v[32:35], v[20:23], v[128:131]
  v_mfma_f32_16x16x32_bf16 v[132:135], v[32:35], v[24:27], v[132:135]
  v_mfma_f32_16x16x32_bf16 v[136:139], v[32:35], v[28:31], v[136:139]
  v_mfma_f32_16x16x32_bf16 v[140:143], v[36:39], v[16:19], v[140:143]
  v_mfma_f32_16x16x32_bf16 v[144:147], v[36:39], v[20:23], v[144:147]
  v_mfma_f32_16x16x32_bf16 v[148:151], v[36:39], v[24:27], v[148:151]
  v_mfma_f32_16x16x32_bf16 v[152:155], v[36:39], v[28:31], v[152:155]
  v_mfma_f32_16x16x32_bf16 v[156:159], v[40:43], v[16:19], v[156:159]
  v_mfma_f32_16x16x32_bf16 v[160:163], v[40:43], v[20:23], v[160:163]
  v_mfma_f32_16x16x32_bf16 v[164:167], v[40:43], v[24:27], v[164:167]
  v_mfma_f32_16x16x32_bf16 v[168:171], v[40:43], v[28:31], v[168:171]
  v_mfma_f32_16x16x32_bf16 v[172:175], v[44:47], v[16:19], v[172:175]
  v_mfma_f32_16x16x32_bf16 v[176:179], v[44:47], v[20:23], v[176:179]
  v_mfma_f32_16x16x32_bf16 v[180:183], v[44:47], v[24:27], v[180:183]
  v_mfma_f32_16x16x32_bf16 v[184:187], v[44:47], v[28:31], v[184:187]
  v_mfma_f32_16x16x32_bf16 v[188:191], v[48:51], v[16:19], v[188:191]
  v_mfma_f32_16x16x32_bf16 v[192:195], v[48:51], v[20:23], v[192:195]
  v_mfma_f32_16x16x32_bf16 v[196:199], v[48:51], v[24:27], v[196:199]
  v_mfma_f32_16x16x32_bf16 v[200:203], v[48:51], v[28:31], v[200:203]
  s_waitcnt vmcnt(1)
  s_cmp_ge_u32 s29, 2
  s_cbranch_scc1 G2_skip
  v_mfma_f32_16x16x32_bf16 v[124:127], v[68:71], v[52:55], v[124:127]
  v_mfma_f32_16x16x32_bf16 v[128:131], v[68:71], v[56:59], v[128:131]
  v_mfma_f32_16x16x32_bf16 v[132:135], v[68:71], v[60:63], v[132:135]
  v_mfma_f32_16x16x32_bf16 v[136:139], v[68:71], v[64:67], v[136:139]
  v_mfma_f32_16x16x32_bf16 v[140:143], v[72:75], v[52:55], v[140:143]
  v_mfma_f32_16x16x32_bf16 v[144:147], v[72:75], v[56:59], v[144:147]
  v_mfma_f32_16x16x32_bf16 v[148:151], v[72:75], v[60:63], v[148:151]
  v_mfma_f32_16x16x32_bf16 v[152:155], v[72:75], v[64:67], v[152:155]
  v_mfma_f32_16x16x32_bf16 v[156:159], v[76:79], v[52:55], v[156:159]
  v_mfma_f32_16x16x32_bf16 v[160:163], v[76:79], v[56:59], v[160:163]
  v_mfma_f32_16x16x32_bf16 v[164:167], v[76:79], v[60:63], v[164:167]
  v_mfma_f32_16x16x32_bf16 v[168:171], v[76:79], v[64:67], v[168:171]
  v_mfma_f32_16x16x32_bf16 v[172:175], v[80:83], v[52:55], v[172:175]
  v_mfma_f32_16x16x32_bf16 v[176:179], v[80:83], v[56:59], v[176:179]
  v_mfma_f32_16x16x32_bf16 v[180:183], v[80:83], v[60:63], v[180:183]
  v_mfma_f32_16x16x32_bf16 v[184:187], v[80:83], v[64:67], v[184:187]
  v_mfma_f32_16x16x32_bf16 v[188:191], v[84:87], v[52:55], v[188:191]
  v_mfma_f32_16x16x32_bf16 v[192:195], v[84:87], v[56:59], v[192:195]
  v_mfma_f32_16x16x32_bf16 v[196:199], v[84:87], v[60:63], v[196:199]
  v_mfma_f32_16x16x32_bf16 v[200:203], v[84:87], v[64:67], v[200:203]
G2_skip:
  s_nop 1
  v_add_u32 v40, s45, v2
  v_lshrrev_b32 v41, 1, v1
  v_lshlrev_b32 v41, 12, v41
  v_and_b32 v42, 1, v1
  v_lshl_add_u32 v41, v42, 4, v41
  v_cmp_gt_u32 vcc, 32, v1
  v_mov_b32 v42, 2130706432
  s_nop 0
  v_cndmask_b32 v42, v42, v41, vcc
  v_lshrrev_b32 v43, 2, v1
  v_lshlrev_b32 v43, 5, v43
  v_and_b32 v44, 3, v1
  v_lshl_add_u32 v43, v44, 3, v43
  v_add_u32 v43, s51, v43
  s_waitcnt vmcnt(0)
  v_readfirstlane_b32 s54, v3
  s_nop 0
  s_cmp_lt_u32 s54, 20
  s_cbranch_scc1 G2_late
  s_mov_b32 m0, s51
  s_nop 0
  buffer_load_dwordx4 v41, s[8:11], s48 offen sc1 lds
  s_add_u32 m0, s51, 1024
  s_nop 0
  buffer_load_dwordx4 v41, s[8:11], s49 offen sc1 lds
  s_add_u32 m0, s51, 2048
  s_nop 0
  buffer_load_dwordx4 v42, s[8:11], s50 offen sc1 lds
G2_late:
  s_cmp_eq_u32 s29, 0
  s_cbranch_scc1 G2_own0
  s_sub_u32 s45, s29, 1
  s_and_b32 s45, s45, 3
  s_add_u32 s45, s45, 0
  s_mul_i32 s45, s45, 5120
  v_add_u32 v46, s45, v2
  ds_write_b128 v46, v[124:127] offset:0
  ds_write_b128 v46, v[140:143] offset:1024
  ds_write_b128 v46, v[156:159] offset:2048
  ds_write_b128 v46, v[172:175] offset:3072
  ds_write_b128 v46, v[188:191] offset:4096
  s_branch G2_nx0
G2_own0:
  v_mov_b32 v16, v124
  v_mov_b32 v17, v125
  v_mov_b32 v18, v126
  v_mov_b32 v19, v127
  v_mov_b32 v20, v140
  v_mov_b32 v21, v141
  v_mov_b32 v22, v142
  v_mov_b32 v23, v143
  v_mov_b32 v24, v156
  v_mov_b32 v25, v157
  v_mov_b32 v26, v158
  v_mov_b32 v27, v159
  v_mov_b32 v28, v172
  v_mov_b32 v29, v173
  v_mov_b32 v30, v174
  v_mov_b32 v31, v175
  v_mov_b32 v32, v188
  v_mov_b32 v33, v189
  v_mov_b32 v34, v190
  v_mov_b32 v35, v191
G2_nx0:
  s_cmp_eq_u32 s29, 1
  s_cbranch_scc1 G2_own1
  s_sub_u32 s45, s29, 2
  s_and_b32 s45, s45, 3
  s_add_u32 s45, s45, 3
  s_mul_i32 s45, s45, 5120
  v_add_u32 v46, s45, v2
  ds_write_b128 v46, v[128:131] offset:0
  ds_write_b128 v46, v[144:147] offset:1024
  ds_write_b128 v46, v[160:163] offset:2048
  ds_write_b128 v46, v[176:179] offset:3072
  ds_write_b128 v46, v[192:195] offset:4096
  s_branch G2_nx1
G2_own1:
  v_mov_b32 v16, v128
  v_mov_b32 v17, v129
  v_mov_b32 v18, v130
  v_mov_b32 v19, v131
  v_mov_b32 v20, v144
  v_mov_b32 v21, v145
  v_mov_b32 v22, v146
  v_mov_b32 v23, v147
  v_mov_b32 v24, v160
  v_mov_b32 v25, v161
  v_mov_b32 v26, v162
  v_mov_b32 v27, v163
  v_mov_b32 v28, v176
  v_mov_b32 v29, v177
  v_mov_b32 v30, v178
  v_mov_b32 v31, v179
  v_mov_b32 v32, v192
  v_mov_b32 v33, v193
  v_mov_b32 v34, v194
  v_mov_b32 v35, v195
G2_nx1:
  s_cmp_eq_u32 s29, 2
  s_cbranch_scc1 G2_own2
  s_sub_u32 s45, s29, 3
  s_and_b32 s45, s45, 3
  s_add_u32 s45, s45, 6
  s_mul_i32 s45, s45, 5120
  v_add_u32 v46, s45, v2
  ds_write_b128 v46, v[132:135] offset:0
  ds_write_b128 v46, v[148:151] offset:1024
  ds_write_b128 v46, v[164:167] offset:2048
  ds_write_b128 v46, v[180:183] offset:3072
  ds_write_b128 v46, v[196:199] offset:4096
  s_branch G2_nx2
G2_own2:
  v_mov_b32 v16, v132
  v_mov_b32 v17, v133
  v_mov_b32 v18, v134
  v_mov_b32 v19, v135
  v_mov_b32 v20, v148
  v_mov_b32 v21, v149
  v_mov_b32 v22, v150
  v_mov_b32 v23, v151
  v_mov_b32 v24, v164
  v_mov_b32 v25, v165
  v_mov_b32 v26, v166
  v_mov_b32 v27, v167
  v_mov_b32 v28, v180
  v_mov_b32 v29, v181
  v_mov_b32 v30, v182
  v_mov_b32 v31, v183
  v_mov_b32 v32, v196
  v_mov_b32 v33, v197
  v_mov_b32 v34, v198
  v_mov_b32 v35, v199
G2_nx2:
  s_cmp_eq_u32 s29, 3
  s_cbranch_scc1 G2_own3
  s_sub_u32 s45, s29, 4
  s_and_b32 s45, s45, 3
  s_add_u32 s45, s45, 9
  s_mul_i32 s45, s45, 5120
  v_add_u32 v46, s45, v2
  ds_write_b128 v46, v[136:139] offset:0
  ds_write_b128 v46, v[152:155] offset:1024
  ds_write_b128 v46, v[168:171] offset:2048
  ds_write_b128 v46, v[184:187] offset:3072
  ds_write_b128 v46, v[200:203] offset:4096
  s_branch G2_nx3
G2_own3:
  v_mov_b32 v16, v136
  v_mov_b32 v17, v137
  v_mov_b32 v18, v138
  v_mov_b32 v19, v139
  v_mov_b32 v20, v152
  v_mov_b32 v21, v153
  v_mov_b32 v22, v154
  v_mov_b32 v23, v155
  v_mov_b32 v24, v168
  v_mov_b32 v25, v169
  v_mov_b32 v26, v170
  v_mov_b32 v27, v171
  v_mov_b32 v28, v184
  v_mov_b32 v29, v185
  v_mov_b32 v30, v186
  v_mov_b32 v31, v187
  v_mov_b32 v32, v200
  v_mov_b32 v33, v201
  v_mov_b32 v34, v202
  v_mov_b32 v35, v203
G2_nx3:
  s_waitcnt lgkmcnt(0)
  s_barrier
  ds_read_b128 v[56:59], v40 offset:0
  ds_read_b128 v[60:63], v40 offset:1024
  ds_read_b128 v[64:67], v40 offset:2048
  ds_read_b128 v[68:71], v40 offset:3072
  ds_read_b128 v[72:75], v40 offset:4096
  ds_read_b128 v[76:79], v40 offset:5120
  ds_read_b128 v[80:83], v40 offset:6144
  ds_read_b128 v[84:87], v40 offset:7168
  ds_read_b128 v[88:91], v40 offset:8192
  ds_read_b128 v[92:95], v40 offset:9216
  ds_read_b128 v[96:99], v40 offset:10240
  ds_read_b128 v[100:103], v40 offset:11264
  ds_read_b128 v[104:107], v40 offset:12288
  ds_read_b128 v[108:111], v40 offset:13312
  ds_read_b128 v[112:115], v40 offset:14336
  v_lshlrev_b32 v124, 16, v4
  v_and_b32 v125, 0xffff0000, v4
  v_pk_add_f32 v[16:17], v[16:17], v[124:125]
  v_lshlrev_b32 v128, 16, v5
  v_and_b32 v129, 0xffff0000, v5
  v_pk_add_f32 v[18:19], v[18:19], v[128:129]
  v_lshlrev_b32 v132, 16, v6
  v_and_b32 v133, 0xffff0000, v6
  v_pk_add_f32 v[20:21], v[20:21], v[132:133]
  v_lshlrev_b32 v136, 16, v7
  v_and_b32 v137, 0xffff0000, v7
  v_pk_add_f32 v[22:23], v[22:23], v[136:137]
  v_lshlrev_b32 v140, 16, v8
  v_and_b32 v141, 0xffff0000, v8
  v_pk_add_f32 v[24:25], v[24:25], v[140:141]
  v_lshlrev_b32 v144, 16, v9
  v_and_b32 v145, 0xffff0000, v9
  v_pk_add_f32 v[26:27], v[26:27], v[144:145]
  v_lshlrev_b32 v148, 16, v10
  v_and_b32 v149, 0xffff0000, v10
  v_pk_add_f32 v[28:29], v[28:29], v[148:149]
  v_lshlrev_b32 v152, 16, v11
  v_and_b32 v153, 0xffff0000, v11
  v_pk_add_f32 v[30:31], v[30:31], v[152:153]
  v_lshlrev_b32 v156, 16, v12
  v_and_b32 v157, 0xffff0000, v12
  v_pk_add_f32 v[32:33], v[32:33], v[156:157]
  v_lshlrev_b32 v160, 16, v13
  v_and_b32 v161, 0xffff0000, v13
  v_pk_add_f32 v[34:35], v[34:35], v[160:161]
  s_waitcnt lgkmcnt(14)
  v_pk_add_f32 v[16:17], v[16:17], v[56:57]
  v_pk_add_f32 v[18:19], v[18:19], v[58:59]
  s_waitcnt lgkmcnt(13)
  v_pk_add_f32 v[20:21], v[20:21], v[60:61]
  v_pk_add_f32 v[22:23], v[22:23], v[62:63]
  s_waitcnt lgkmcnt(12)
  v_pk_add_f32 v[24:25], v[24:25], v[64:65]
  v_pk_add_f32 v[26:27], v[26:27], v[66:67]
  s_waitcnt lgkmcnt(11)
  v_pk_add_f32 v[28:29], v[28:29], v[68:69]
  v_pk_add_f32 v[30:31], v[30:31], v[70:71]
  s_waitcnt lgkmcnt(10)
  v_pk_add_f32 v[32:33], v[32:33], v[72:73]
  v_pk_add_f32 v[34:35], v[34:35], v[74:75]
  s_waitcnt lgkmcnt(9)
  v_pk_add_f32 v[16:17], v[16:17], v[76:77]
  v_pk_add_f32 v[18:19], v[18:19], v[78:79]
  s_waitcnt lgkmcnt(8)
  v_pk_add_f32 v[20:21], v[20:21], v[80:81]
  v_pk_add_f32 v[22:23], v[22:23], v[82:83]
  s_waitcnt lgkmcnt(7)
  v_pk_add_f32 v[24:25], v[24:25], v[84:85]
  v_pk_add_f32 v[26:27], v[26:27], v[86:87]
  s_waitcnt lgkmcnt(6)
  v_pk_add_f32 v[28:29], v[28:29], v[88:89]
  v_pk_add_f32 v[30:31], v[30:31], v[90:91]
  s_waitcnt lgkmcnt(5)
  v_pk_add_f32 v[32:33], v[32:33], v[92:93]
  v_pk_add_f32 v[34:35], v[34:35], v[94:95]
  s_waitcnt lgkmcnt(4)
  v_pk_add_f32 v[16:17], v[16:17], v[96:97]
  v_pk_add_f32 v[18:19], v[18:19], v[98:99]
  s_waitcnt lgkmcnt(3)
  v_pk_add_f32 v[20:21], v[20:21], v[100:101]
  v_pk_add_f32 v[22:23], v[22:23], v[102:103]
  s_waitcnt lgkmcnt(2)
  v_pk_add_f32 v[24:25], v[24:25], v[104:105]
  v_pk_add_f32 v[26:27], v[26:27], v[106:107]
  s_waitcnt lgkmcnt(1)
  v_pk_add_f32 v[28:29], v[28:29], v[108:109]
  v_pk_add_f32 v[30:31], v[30:31], v[110:111]
  s_waitcnt lgkmcnt(0)
  v_pk_add_f32 v[32:33], v[32:33], v[112:113]
  v_pk_add_f32 v[34:35], v[34:35], v[114:115]
  v_mul_f32 v124, 0xbfb8aa3b, v16
  v_mul_f32 v125, 0xbfb8aa3b, v17
  v_exp_f32 v124, v124
  v_exp_f32 v125, v125
  v_mul_f32 v128, 0xbfb8aa3b, v18
  v_mul_f32 v129, 0xbfb8aa3b, v19
  v_exp_f32 v128, v128
  v_exp_f32 v129, v129
  v_mul_f32 v132, 0xbfb8aa3b, v20
  v_mul_f32 v133, 0xbfb8aa3b, v21
  v_exp_f32 v132, v132
  v_exp_f32 v133, v133
  v_mul_f32 v136, 0xbfb8aa3b, v22
  v_mul_f32 v137, 0xbfb8aa3b, v23
  v_exp_f32 v136, v136
  v_exp_f32 v137, v137
  v_mul_f32 v140, 0xbfb8aa3b, v24
  v_mul_f32 v141, 0xbfb8aa3b, v25
  v_exp_f32 v140, v140
  v_exp_f32 v141, v141
  v_mul_f32 v144, 0xbfb8aa3b, v26
  v_mul_f32 v145, 0xbfb8aa3b, v27
  v_exp_f32 v144, v144
  v_exp_f32 v145, v145
  v_mul_f32 v148, 0xbfb8aa3b, v28
  v_mul_f32 v149, 0xbfb8aa3b, v29
  v_exp_f32 v148, v148
  v_exp_f32 v149, v149
  v_mul_f32 v152, 0xbfb8aa3b, v30
  v_mul_f32 v153, 0xbfb8aa3b, v31
  v_exp_f32 v152, v152
  v_exp_f32 v153, v153
  v_mul_f32 v156, 0xbfb8aa3b, v32
  v_mul_f32 v157, 0xbfb8aa3b, v33
  v_exp_f32 v156, v156
  v_exp_f32 v157, v157
  v_mul_f32 v160, 0xbfb8aa3b, v34
  v_mul_f32 v161, 0xbfb8aa3b, v35
  v_exp_f32 v160, v160
  v_exp_f32 v161, v161
  s_cmp_lt_u32 s54, 20
  s_cbranch_scc0 G2_pollok
G2_poll:
  buffer_load_dword v3, off, s[8:11], s46 sc1
  s_add_u32 s47, s47, 1
  s_waitcnt vmcnt(0)
  v_readfirstlane_b32 s54, v3
  s_cmp_lt_u32 s47, 0x20000
  s_cselect_b32 s55, s54, 20
  s_cmp_lt_u32 s55, 20
  s_cbranch_scc0 G2_go
  s_sleep 1
  s_branch G2_poll
G2_go:
  s_mov_b32 m0, s51
  s_nop 0
  buffer_load_dwordx4 v41, s[8:11], s48 offen sc1 lds
  s_add_u32 m0, s51, 1024
  s_nop 0
  buffer_load_dwordx4 v41, s[8:11], s49 offen sc1 lds
  s_add_u32 m0, s51, 2048
  s_nop 0
  buffer_load_dwordx4 v42, s[8:11], s50 offen sc1 lds
G2_pollok:
  v_add_f32 v124, 1.0, v124
  v_add_f32 v125, 1.0, v125
  v_rcp_f32 v124, v124
  v_rcp_f32 v125, v125
  v_add_f32 v128, 1.0, v128
  v_add_f32 v129, 1.0, v129
  v_rcp_f32 v128, v128
  v_rcp_f32 v129, v129
  v_add_f32 v132, 1.0, v132
  v_add_f32 v133, 1.0, v133
  v_rcp_f32 v132, v132
  v_rcp_f32 v133, v133
  v_add_f32 v136, 1.0, v136
  v_add_f32 v137, 1.0, v137
  v_rcp_f32 v136, v136
  v_rcp_f32 v137, v137
  v_add_f32 v140, 1.0, v140
  v_add_f32 v141, 1.0, v141
  v_rcp_f32 v140, v140
  v_rcp_f32 v141, v141
  v_add_f32 v144, 1.0, v144
  v_add_f32 v145, 1.0, v145
  v_rcp_f32 v144, v144
  v_rcp_f32 v145, v145
  v_add_f32 v148, 1.0, v148
  v_add_f32 v149, 1.0, v149
  v_rcp_f32 v148, v148
  v_rcp_f32 v149, v149
  v_add_f32 v152, 1.0, v152
  v_add_f32 v153, 1.0, v153
  v_rcp_f32 v152, v152
  v_rcp_f32 v153, v153
  v_add_f32 v156, 1.0, v156
  v_add_f32 v157, 1.0, v157
  v_rcp_f32 v156, v156
  v_rcp_f32 v157, v157
  v_add_f32 v160, 1.0, v160
  v_add_f32 v161, 1.0, v161
  v_rcp_f32 v160, v160
  v_rcp_f32 v161, v161
  v_pk_mul_f32 v[16:17], v[16:17], v[124:125]
  v_lshlrev_b32 v126, 16, v244
  v_and_b32 v127, 0xffff0000, v244
  v_pk_mul_f32 v[18:19], v[18:19], v[128:129]
  v_lshlrev_b32 v130, 16, v245
  v_and_b32 v131, 0xffff0000, v245
  v_pk_mul_f32 v[20:21], v[20:21], v[132:133]
  v_lshlrev_b32 v134, 16, v246
  v_and_b32 v135, 0xffff0000, v246
  v_pk_mul_f32 v[22:23], v[22:23], v[136:137]
  v_lshlrev_b32 v138, 16, v247
  v_and_b32 v139, 0xffff0000, v247
  v_pk_mul_f32 v[24:25], v[24:25], v[140:141]
  v_lshlrev_b32 v142, 16, v248
  v_and_b32 v143, 0xffff0000, v248
  v_pk_mul_f32 v[26:27], v[26:27], v[144:145]
  v_lshlrev_b32 v146, 16, v249
  v_and_b32 v147, 0xffff0000, v249
  v_pk_mul_f32 v[28:29], v[28:29], v[148:149]
  v_lshlrev_b32 v150, 16, v250
  v_and_b32 v151, 0xffff0000, v250
  v_pk_mul_f32 v[30:31], v[30:31], v[152:153]
  v_lshlrev_b32 v154, 16, v251
  v_and_b32 v155, 0xffff0000, v251
  v_pk_mul_f32 v[32:33], v[32:33], v[156:157]
  v_lshlrev_b32 v158, 16, v252
  v_and_b32 v159, 0xffff0000, v252
  v_pk_mul_f32 v[34:35], v[34:35], v[160:161]
  v_lshlrev_b32 v162, 16, v253
  v_and_b32 v163, 0xffff0000, v253
  s_waitcnt vmcnt(0)
  ds_read_b64_tr_b16 v[44:45], v43 offset:0
  ds_read_b64_tr_b16 v[46:47], v43 offset:512
  ds_read_b64_tr_b16 v[48:49], v43 offset:1024
  ds_read_b64_tr_b16 v[50:51], v43 offset:1536
  ds_read_b64_tr_b16 v[52:53], v43 offset:2048
  s_waitcnt lgkmcnt(4)
  v_lshlrev_b32 v124, 16, v44
  v_and_b32 v125, 0xffff0000, v44
  v_pk_fma_f32 v[124:125], v[124:125], v[16:17], v[126:127]
  v_cvt_pk_bf16_f32 v56, v124, v125
  v_lshlrev_b32 v128, 16, v45
  v_and_b32 v129, 0xffff0000, v45
  v_pk_fma_f32 v[128:129], v[128:129], v[18:19], v[130:131]
  v_cvt_pk_bf16_f32 v57, v128, v129
  buffer_store_dwordx2 v[56:57], v254, s[24:27], s44 offen offset:0
  s_waitcnt lgkmcnt(3)
  v_lshlrev_b32 v132, 16, v46
  v_and_b32 v133, 0xffff0000, v46
  v_pk_fma_f32 v[132:133], v[132:133], v[20:21], v[134:135]
  v_cvt_pk_bf16_f32 v58, v132, v133
  v_lshlrev_b32 v136, 16, v47
  v_and_b32 v137, 0xffff0000, v47
  v_pk_fma_f32 v[136:137], v[136:137], v[22:23], v[138:139]
  v_cvt_pk_bf16_f32 v59, v136, v137
  buffer_store_dwordx2 v[58:59], v254, s[24:27], s44 offen offset:32
  s_waitcnt lgkmcnt(2)
  v_lshlrev_b32 v140, 16, v48
  v_and_b32 v141, 0xffff0000, v48
  v_pk_fma_f32 v[140:141], v[140:141], v[24:25], v[142:143]
  v_cvt_pk_bf16_f32 v60, v140, v141
  v_lshlrev_b32 v144, 16, v49
  v_and_b32 v145, 0xffff0000, v49
  v_pk_fma_f32 v[144:145], v[144:145], v[26:27], v[146:147]
  v_cvt_pk_bf16_f32 v61, v144, v145
  buffer_store_dwordx2 v[60:61], v254, s[24:27], s44 offen offset:64
  s_waitcnt lgkmcnt(1)
  v_lshlrev_b32 v148, 16, v50
  v_and_b32 v149, 0xffff0000, v50
  v_pk_fma_f32 v[148:149], v[148:149], v[28:29], v[150:151]
  v_cvt_pk_bf16_f32 v62, v148, v149
  v_lshlrev_b32 v152, 16, v51
  v_and_b32 v153, 0xffff0000, v51
  v_pk_fma_f32 v[152:153], v[152:153], v[30:31], v[154:155]
  v_cvt_pk_bf16_f32 v63, v152, v153
  buffer_store_dwordx2 v[62:63], v254, s[24:27], s44 offen offset:96
  s_waitcnt lgkmcnt(0)
  v_lshlrev_b32 v156, 16, v52
  v_and_b32 v157, 0xffff0000, v52
  v_pk_fma_f32 v[156:157], v[156:157], v[32:33], v[158:159]
  v_cvt_pk_bf16_f32 v64, v156, v157
  v_lshlrev_b32 v160, 16, v53
  v_and_b32 v161, 0xffff0000, v53
  v_pk_fma_f32 v[160:161], v[160:161], v[34:35], v[162:163]
  v_cvt_pk_bf16_f32 v65, v160, v161
  buffer_store_dwordx2 v[64:65], v254, s[24:27], s44 offen offset:128
  s_endpgm
C_role:
  s_load_dwordx2 s[28:29], s[0:1], 8
  s_load_dwordx2 s[32:33], s[0:1], 16
  s_load_dwordx2 s[36:37], s[0:1], 24
  s_load_dwordx2 s[40:41], s[0:1], 32
  s_load_dwordx2 s[44:45], s[0:1], 40
  s_load_dwordx2 s[48:49], s[0:1], 48
  s_load_dwordx2 s[52:53], s[0:1], 56
  s_load_dwordx2 s[56:57], s[0:1], 64
  s_load_dwordx2 s[8:9], s[0:1], 128
  s_mov_b32 s30, 163840
  s_mov_b32 s31, 0x20000
  s_mov_b32 s34, 163840
  s_mov_b32 s35, 0x20000
  s_mov_b32 s38, 163840
  s_mov_b32 s39, 0x20000
  s_mov_b32 s42, 163840
  s_mov_b32 s43, 0x20000
  s_mov_b32 s46, 163840
  s_mov_b32 s47, 0x20000
  s_mov_b32 s50, 163840
  s_mov_b32 s51, 0x20000
  s_mov_b32 s54, 1280
  s_mov_b32 s55, 0x20000
  s_mov_b32 s58, 1280
  s_mov_b32 s59, 0x20000
  s_mov_b32 s10, 19922944
  s_mov_b32 s11, 0x20000
  s_setprio 3
  v_lshrrev_b32 v4, 6, v0
  v_and_b32 v1, 63, v0
  v_lshlrev_b32 v2, 2, v1
  v_readfirstlane_b32 s16, v4
  v_lshrrev_b32 v7, 1, v1
  v_mul_u32_u24 v7, 20480, v7
  v_and_b32 v3, 1, v1
  v_lshl_add_u32 v7, v3, 4, v7
  s_lshl_b32 s17, s2, 2
  s_add_u32 s17, s17, s16
  s_mul_i32 s18, s16, 17408
  s_lshl_b32 s19, s17, 5
  s_add_u32 s19, s19, 9961472
  s_lshl_b32 s20, s17, 8
  s_lshl_b32 s21, s17, 1
  s_waitcnt lgkmcnt(0)
  buffer_load_dword v8, v2, s[28:31], s20 offen
  buffer_load_dword v9, v2, s[32:35], s20 offen
  buffer_load_dword v10, v2, s[36:39], s20 offen
  buffer_load_dword v11, v2, s[40:43], s20 offen
  buffer_load_dword v12, v2, s[44:47], s20 offen
  buffer_load_dword v13, v2, s[48:51], s20 offen
  buffer_load_ushort v14, off, s[52:55], s21
  buffer_load_ushort v15, off, s[56:59], s21
  buffer_load_dwordx4 v[176:179], v7, s[8:11], s19 offen
  s_add_u32 s19, s19, 655360
  buffer_load_dwordx4 v[180:183], v7, s[8:11], s19 offen
  s_add_u32 s19, s19, 655360
  buffer_load_dwordx4 v[184:187], v7, s[8:11], s19 offen
  s_add_u32 s19, s19, 655360
  buffer_load_dwordx4 v[188:191], v7, s[8:11], s19 offen
  v_mov_b32 v128, 0
  v_mov_b32 v129, 0
  v_mov_b32 v130, 0
  v_mov_b32 v131, 0
  v_mov_b32 v132, 0
  v_mov_b32 v133, 0
  v_mov_b32 v134, 0
  v_mov_b32 v135, 0
  v_mov_b32 v136, 0
  v_mov_b32 v137, 0
  v_mov_b32 v138, 0
  v_mov_b32 v139, 0
  v_mov_b32 v140, 0
  v_mov_b32 v141, 0
  v_mov_b32 v142, 0
  v_mov_b32 v143, 0
  v_mov_b32 v64, 0
  v_mov_b32 v65, 0
  v_mov_b32 v66, 0
  v_mov_b32 v67, 0
  v_mov_b32 v68, 0
  v_mov_b32 v69, 0
  v_mov_b32 v70, 0
  v_mov_b32 v71, 0
  v_mov_b32 v72, 0
  v_mov_b32 v73, 0
  v_mov_b32 v74, 0
  v_mov_b32 v75, 0
  v_mov_b32 v76, 0
  v_mov_b32 v77, 0
  v_mov_b32 v78, 0
  v_mov_b32 v79, 0
  v_mov_b32 v80, 0
  v_mov_b32 v81, 0
  v_mov_b32 v82, 0
  v_mov_b32 v83, 0
  v_mov_b32 v84, 0
  v_mov_b32 v85, 0
  v_mov_b32 v86, 0
  v_mov_b32 v87, 0
  v_mov_b32 v88, 0
  v_mov_b32 v89, 0
  v_mov_b32 v90, 0
  v_mov_b32 v91, 0
  v_mov_b32 v92, 0
  v_mov_b32 v93, 0
  v_mov_b32 v94, 0
  v_mov_b32 v95, 0
  v_mov_b32 v96, 0
  v_mov_b32 v97, 0
  v_mov_b32 v98, 0
  v_mov_b32 v99, 0
  v_mov_b32 v100, 0
  v_mov_b32 v101, 0
  v_mov_b32 v102, 0
  v_mov_b32 v103, 0
  v_mov_b32 v104, 0
  v_mov_b32 v105, 0
  v_mov_b32 v106, 0
  v_mov_b32 v107, 0
  v_mov_b32 v108, 0
  v_mov_b32 v109, 0
  v_mov_b32 v110, 0
  v_mov_b32 v111, 0
  v_mov_b32 v112, 0
  v_mov_b32 v113, 0
  v_mov_b32 v114, 0
  v_mov_b32 v115, 0
  v_mov_b32 v116, 0
  v_mov_b32 v117, 0
  v_mov_b32 v118, 0
  v_mov_b32 v119, 0
  v_mov_b32 v120, 0
  v_mov_b32 v121, 0
  v_mov_b32 v122, 0
  v_mov_b32 v123, 0
  v_mov_b32 v124, 0
  v_mov_b32 v125, 0
  v_mov_b32 v126, 0
  v_mov_b32 v127, 0
  v_add_u32 v3, s18, v2
  v_add_u32 v212, 0, v3
  v_add_u32 v213, 1088, v3
  v_add_u32 v214, 2176, v3
  v_add_u32 v215, 3264, v3
  v_add_u32 v216, 4352, v3
  v_add_u32 v217, 5440, v3
  v_add_u32 v218, 6528, v3
  v_add_u32 v219, 7616, v3
  v_add_u32 v220, 8704, v3
  v_add_u32 v221, 9792, v3
  v_add_u32 v222, 10880, v3
  v_add_u32 v223, 11968, v3
  v_add_u32 v224, 13056, v3
  v_add_u32 v225, 14144, v3
  v_add_u32 v226, 15232, v3
  v_add_u32 v227, 16320, v3
  v_and_b32 v5, 31, v0
  v_bfe_u32 v6, v0, 5, 1
  v_lshlrev_b32 v7, 4, v5
  v_lshl_add_u32 v7, v6, 9, v7
  v_sub_u32 v7, 11312, v7
  v_add_u32 v245, s18, v7
  v_mul_u32_u24 v5, 272, v5
  v_lshl_add_u32 v5, v6, 4, v5
  v_add_u32 v5, s18, v5
  v_lshlrev_b32 v7, 4, v1
  v_add_u32 v246, s18, v7
  v_and_b32 v6, 15, v1
  v_lshrrev_b32 v7, 4, v1
  v_add_u32 v16, 1, v6
  v_and_b32 v17, 1, v16
  v_mul_u32_u24 v17, 5184, v17
  v_and_b32 v16, 0x1e, v16
  v_lshl_add_u32 v17, v16, 1, v17
  v_lshl_add_u32 v17, v7, 4, v17
  v_add_u32 v240, s18, v17
  v_add_u32 v241, 1024, v240
  v_add_u32 v242, 2048, v240
  v_add_u32 v243, 3072, v240
  v_lshlrev_b32 v16, 5, v6
  v_lshl_add_u32 v247, v7, 3, v16
  v_sub_u32 v16, 10784, v16
  v_lshl_add_u32 v16, v7, 4, v16
  v_add_u32 v244, s18, v16
  v_mov_b32 v16, 0x3f80
  ds_write_b32 v3, v16 offset:8704
  s_lshl_b32 s21, s17, 12
  s_add_u32 s21, s21, 15728640
  s_mul_i32 s65, s2, 3277
  s_lshr_b32 s65, s65, 16
  s_lshl_b32 s65, s65, 10
  s_add_u32 s65, s65, 19005440
  s_mov_b32 s60, 0
  s_mov_b32 s61, -1
  s_mov_b32 s62, 0
  s_mov_b32 s63, 0xaaaaaaaa
  s_mov_b64 s[22:23], exec
  s_mov_b32 s64, 0x05040c0c
  s_waitcnt vmcnt(4)
  v_lshlrev_b32 v14, 16, v14
  v_mul_f32 v14, 0x3fb8aa3b, v14
  v_exp_f32 v14, v14
  v_lshlrev_b32 v15, 16, v15
  v_cmp_eq_u32 vcc, 0, v1
  s_nop 1
  v_cndmask_b32 v15, 0, v15, vcc
  v_cvt_pk_bf16_f32 v14, v14, v14
  v_and_b32 v14, 0xffff0000, v14
K_half:
  v_perm_b32 v16, v8, v8, s64
  v_perm_b32 v17, v9, v9, s64
  v_perm_b32 v18, v10, v10, s64
  v_pk_mul_f32 v[16:17], v[16:17], v[14:15] op_sel_hi:[1,0]
  v_perm_b32 v19, v11, v11, s64
  v_mul_f32 v17, 0x3e22f983, v17
  v_mul_f32 v16, 0x3fb8aa3b, v16
  s_waitcnt lgkmcnt(14)
  v_mfma_f32_32x32x16_bf16 v[128:143], v[64:67], v[68:71], v[128:143]
  v_mul_f32 v21, 0x41000000, v17
  v_mul_f32 v23, 0x3f800000, v17
  v_fract_f32 v21, v21
  s_waitcnt lgkmcnt(12)
  v_mfma_f32_32x32x16_bf16 v[128:143], v[72:75], v[76:79], v[128:143]
  v_mul_f32 v20, 0x41000000, v16
  v_cos_f32 v24, v21
  v_exp_f32 v20, v20
  s_waitcnt lgkmcnt(10)
  v_mfma_f32_32x32x16_bf16 v[128:143], v[80:83], v[84:87], v[128:143]
  v_sin_f32 v25, v21
  v_mul_f32 v27, 0x43800000, v17
  v_fract_f32 v23, v23
  s_waitcnt lgkmcnt(8)
  v_mfma_f32_32x32x16_bf16 v[128:143], v[88:91], v[92:95], v[128:143]
  v_pk_mul_f32 v[28:29], v[24:25], v[20:21] op_sel_hi:[1,0] neg_hi:[1,0]
  v_fract_f32 v27, v27
  v_pk_mul_f32 v[30:31], v[28:29], v[28:29] op_sel_hi:[1,0]
  s_waitcnt lgkmcnt(6)
  v_mfma_f32_32x32x16_bf16 v[128:143], v[96:99], v[100:103], v[128:143]
  v_perm_b32 v32, v12, v12, s64
  v_mul_f32 v22, 0x3f800000, v16
  v_mul_f32 v26, 0x43800000, v16
  s_waitcnt lgkmcnt(4)
  v_mfma_f32_32x32x16_bf16 v[128:143], v[104:107], v[108:111], v[128:143]
  v_perm_b32 v33, v13, v13, s64
  v_pk_mul_f32 v[18:19], v[18:19], v[14:15] op_sel_hi:[1,0]
  v_cos_f32 v34, v23
  s_waitcnt lgkmcnt(2)
  v_mfma_f32_32x32x16_bf16 v[128:143], v[112:115], v[116:119], v[128:143]
  v_cos_f32 v36, v27
  v_pk_fma_f32 v[30:31], v[28:29], v[28:29], v[30:31] op_sel:[1,1,0] op_sel_hi:[0,1,1] neg_lo:[1,0,0]
  v_exp_f32 v22, v22
  s_waitcnt lgkmcnt(0)
  v_mfma_f32_32x32x16_bf16 v[128:143], v[120:123], v[124:127], v[128:143]
  v_sin_f32 v35, v23
  v_exp_f32 v26, v26
  v_sin_f32 v37, v27
  v_pk_mul_f32 v[38:39], v[32:33], v[18:19] op_sel_hi:[1,0]
  v_pk_mul_f32 v[40:41], v[30:31], v[28:29] op_sel_hi:[1,0]
  v_pk_mul_f32 v[42:43], v[30:31], v[30:31] op_sel_hi:[1,0]
  v_pk_fma_f32 v[38:39], v[32:33], v[18:19], v[38:39] op_sel:[1,1,0] op_sel_hi:[0,1,1] neg_lo:[1,0,0]
  v_pk_mul_f32 v[34:35], v[34:35], v[22:23] op_sel_hi:[1,0]
  v_pk_mul_f32 v[36:37], v[36:37], v[26:27] op_sel_hi:[1,0]
  v_pk_fma_f32 v[40:41], v[30:31], v[28:29], v[40:41] op_sel:[1,1,0] op_sel_hi:[0,1,1] neg_lo:[1,0,0]
  v_cvt_pk_bf16_f32 v248, v38, v39
  v_pk_fma_f32 v[42:43], v[30:31], v[30:31], v[42:43] op_sel:[1,1,0] op_sel_hi:[0,1,1] neg_lo:[1,0,0]
  v_cvt_pk_bf16_f32 v249, v40, v41
  v_pk_mul_f32 v[44:45], v[28:29], v[42:43] op_sel_hi:[1,0]
  ds_write_b32 v3, v249 offset:9520
  v_pk_mul_f32 v[46:47], v[30:31], v[42:43] op_sel_hi:[1,0]
  v_cvt_pk_bf16_f32 v250, v28, v29
  v_pk_mul_f32 v[48:49], v[40:41], v[42:43] op_sel_hi:[1,0]
  v_cvt_pk_bf16_f32 v251, v30, v31
  v_pk_mul_f32 v[50:51], v[42:43], v[42:43] op_sel_hi:[1,0]
  ds_write2_b32 v220, v250, v251 offset0:68 offset1:136
  v_pk_mul_f32 v[52:53], v[34:35], v[34:35] op_sel_hi:[1,0]
  v_cvt_pk_bf16_f32 v252, v42, v43
  v_pk_mul_f32 v[54:55], v[36:37], v[36:37] op_sel_hi:[1,0]
  v_pk_mul_f32 v[56:57], v[38:39], v[36:37] op_sel_hi:[1,0]
  v_pk_fma_f32 v[44:45], v[28:29], v[42:43], v[44:45] op_sel:[1,1,0] op_sel_hi:[0,1,1] neg_lo:[1,0,0]
  v_pk_fma_f32 v[46:47], v[30:31], v[42:43], v[46:47] op_sel:[1,1,0] op_sel_hi:[0,1,1] neg_lo:[1,0,0]
  v_pk_fma_f32 v[48:49], v[40:41], v[42:43], v[48:49] op_sel:[1,1,0] op_sel_hi:[0,1,1] neg_lo:[1,0,0]
  v_cvt_pk_bf16_f32 v253, v44, v45
  v_pk_fma_f32 v[50:51], v[42:43], v[42:43], v[50:51] op_sel:[1,1,0] op_sel_hi:[0,1,1] neg_lo:[1,0,0]
  ds_write2_b32 v221, v252, v253 offset0:0 offset1:68
  v_pk_fma_f32 v[52:53], v[34:35], v[34:35], v[52:53] op_sel:[1,1,0] op_sel_hi:[0,1,1] neg_lo:[1,0,0]
  v_cvt_pk_bf16_f32 v254, v46, v47
  v_pk_fma_f32 v[54:55], v[36:37], v[36:37], v[54:55] op_sel:[1,1,0] op_sel_hi:[0,1,1] neg_lo:[1,0,0]
  v_cvt_pk_bf16_f32 v255, v48, v49
  v_pk_fma_f32 v[56:57], v[38:39], v[36:37], v[56:57] op_sel:[1,1,0] op_sel_hi:[0,1,1] neg_lo:[1,0,0]
  ds_write2_b32 v221, v254, v255 offset0:136 offset1:204
  v_pk_mul_f32 v[58:59], v[28:29], v[50:51] op_sel_hi:[1,0]
  v_cvt_pk_bf16_f32 v249, v56, v57
  v_pk_mul_f32 v[60:61], v[30:31], v[50:51] op_sel_hi:[1,0]
  v_cvt_pk_bf16_f32 v250, v50, v51
  v_pk_mul_f32 v[62:63], v[40:41], v[50:51] op_sel_hi:[1,0]
  v_pk_mul_f32 v[144:145], v[42:43], v[50:51] op_sel_hi:[1,0]
  v_pk_mul_f32 v[146:147], v[44:45], v[50:51] op_sel_hi:[1,0]
  v_pk_mul_f32 v[148:149], v[46:47], v[50:51] op_sel_hi:[1,0]
  v_pk_mul_f32 v[150:151], v[48:49], v[50:51] op_sel_hi:[1,0]
  v_pk_mul_f32 v[152:153], v[52:53], v[52:53] op_sel_hi:[1,0]
  v_pk_mul_f32 v[154:155], v[38:39], v[34:35] op_sel_hi:[1,0]
  v_pk_mul_f32 v[156:157], v[54:55], v[54:55] op_sel_hi:[1,0]
  v_pk_mul_f32 v[158:159], v[38:39], v[54:55] op_sel_hi:[1,0]
  v_pk_mul_f32 v[160:161], v[56:57], v[54:55] op_sel_hi:[1,0]
  v_pk_fma_f32 v[58:59], v[28:29], v[50:51], v[58:59] op_sel:[1,1,0] op_sel_hi:[0,1,1] neg_lo:[1,0,0]
  v_pk_fma_f32 v[60:61], v[30:31], v[50:51], v[60:61] op_sel:[1,1,0] op_sel_hi:[0,1,1] neg_lo:[1,0,0]
  v_pk_fma_f32 v[62:63], v[40:41], v[50:51], v[62:63] op_sel:[1,1,0] op_sel_hi:[0,1,1] neg_lo:[1,0,0]
  v_cvt_pk_bf16_f32 v251, v58, v59
  v_pk_fma_f32 v[144:145], v[42:43], v[50:51], v[144:145] op_sel:[1,1,0] op_sel_hi:[0,1,1] neg_lo:[1,0,0]
  ds_write2_b32 v222, v250, v251 offset0:0 offset1:68
  v_pk_fma_f32 v[146:147], v[44:45], v[50:51], v[146:147] op_sel:[1,1,0] op_sel_hi:[0,1,1] neg_lo:[1,0,0]
  v_cvt_pk_bf16_f32 v252, v60, v61
  v_pk_fma_f32 v[148:149], v[46:47], v[50:51], v[148:149] op_sel:[1,1,0] op_sel_hi:[0,1,1] neg_lo:[1,0,0]
  v_cvt_pk_bf16_f32 v253, v62, v63
  v_pk_fma_f32 v[150:151], v[48:49], v[50:51], v[150:151] op_sel:[1,1,0] op_sel_hi:[0,1,1] neg_lo:[1,0,0]
  ds_write2_b32 v222, v252, v253 offset0:136 offset1:204
  v_pk_fma_f32 v[152:153], v[52:53], v[52:53], v[152:153] op_sel:[1,1,0] op_sel_hi:[0,1,1] neg_lo:[1,0,0]
  v_cvt_pk_bf16_f32 v254, v144, v145
  v_pk_fma_f32 v[154:155], v[38:39], v[34:35], v[154:155] op_sel:[1,1,0] op_sel_hi:[0,1,1] neg_lo:[1,0,0]
  v_cvt_pk_bf16_f32 v255, v146, v147
  v_pk_fma_f32 v[156:157], v[54:55], v[54:55], v[156:157] op_sel:[1,1,0] op_sel_hi:[0,1,1] neg_lo:[1,0,0]
  ds_write2_b32 v223, v254, v255 offset0:0 offset1:68
  v_pk_fma_f32 v[158:159], v[38:39], v[54:55], v[158:159] op_sel:[1,1,0] op_sel_hi:[0,1,1] neg_lo:[1,0,0]
  v_cvt_pk_bf16_f32 v250, v154, v155
  v_pk_fma_f32 v[160:161], v[56:57], v[54:55], v[160:161] op_sel:[1,1,0] op_sel_hi:[0,1,1] neg_lo:[1,0,0]
  ds_write2_b32 v212, v248, v250 offset0:0 offset1:68
  v_pk_mul_f32 v[162:163], v[50:51], v[50:51] op_sel_hi:[1,0]
  v_cvt_pk_bf16_f32 v251, v158, v159
  v_pk_mul_f32 v[164:165], v[58:59], v[50:51] op_sel_hi:[1,0]
  v_cvt_pk_bf16_f32 v252, v160, v161
  v_pk_mul_f32 v[166:167], v[60:61], v[50:51] op_sel_hi:[1,0]
  v_cvt_pk_bf16_f32 v253, v148, v149
  v_pk_mul_f32 v[168:169], v[62:63], v[50:51] op_sel_hi:[1,0]
  v_cvt_pk_bf16_f32 v254, v150, v151
  v_pk_mul_f32 v[170:171], v[144:145], v[50:51] op_sel_hi:[1,0]
  ds_write2_b32 v223, v253, v254 offset0:136 offset1:204
  v_pk_mul_f32 v[172:173], v[146:147], v[50:51] op_sel_hi:[1,0]
  v_pk_mul_f32 v[174:175], v[148:149], v[50:51] op_sel_hi:[1,0]
  v_pk_mul_f32 v[228:229], v[150:151], v[50:51] op_sel_hi:[1,0]
  v_pk_mul_f32 v[230:231], v[38:39], v[52:53] op_sel_hi:[1,0]
  v_pk_mul_f32 v[232:233], v[154:155], v[52:53] op_sel_hi:[1,0]
  v_pk_mul_f32 v[234:235], v[38:39], v[156:157] op_sel_hi:[1,0]
  v_pk_mul_f32 v[236:237], v[56:57], v[156:157] op_sel_hi:[1,0]
  v_pk_mul_f32 v[238:239], v[158:159], v[156:157] op_sel_hi:[1,0]
  v_pk_mul_f32 v[16:17], v[160:161], v[156:157] op_sel_hi:[1,0]
  v_pk_mul_f32 v[32:33], v[56:57], v[152:153] op_sel_hi:[1,0]
  v_pk_mul_f32 v[24:25], v[24:25], v[20:21] op_sel_hi:[1,0]
  v_pk_fma_f32 v[162:163], v[50:51], v[50:51], v[162:163] op_sel:[1,1,0] op_sel_hi:[0,1,1] neg_lo:[1,0,0]
  v_pk_fma_f32 v[164:165], v[58:59], v[50:51], v[164:165] op_sel:[1,1,0] op_sel_hi:[0,1,1] neg_lo:[1,0,0]
  v_cvt_pk_bf16_f32 v255, v162, v163
  v_pk_fma_f32 v[166:167], v[60:61], v[50:51], v[166:167] op_sel:[1,1,0] op_sel_hi:[0,1,1] neg_lo:[1,0,0]
  v_cvt_pk_bf16_f32 v248, v164, v165
  v_pk_fma_f32 v[168:169], v[62:63], v[50:51], v[168:169] op_sel:[1,1,0] op_sel_hi:[0,1,1] neg_lo:[1,0,0]
  ds_write2_b32 v224, v255, v248 offset0:0 offset1:68
  v_pk_fma_f32 v[170:171], v[144:145], v[50:51], v[170:171] op_sel:[1,1,0] op_sel_hi:[0,1,1] neg_lo:[1,0,0]
  v_cvt_pk_bf16_f32 v250, v166, v167
  v_pk_fma_f32 v[172:173], v[146:147], v[50:51], v[172:173] op_sel:[1,1,0] op_sel_hi:[0,1,1] neg_lo:[1,0,0]
  v_cvt_pk_bf16_f32 v253, v168, v169
  v_pk_fma_f32 v[174:175], v[148:149], v[50:51], v[174:175] op_sel:[1,1,0] op_sel_hi:[0,1,1] neg_lo:[1,0,0]
  ds_write2_b32 v224, v250, v253 offset0:136 offset1:204
  v_pk_fma_f32 v[228:229], v[150:151], v[50:51], v[228:229] op_sel:[1,1,0] op_sel_hi:[0,1,1] neg_lo:[1,0,0]
  v_cvt_pk_bf16_f32 v254, v170, v171
  v_pk_fma_f32 v[230:231], v[38:39], v[52:53], v[230:231] op_sel:[1,1,0] op_sel_hi:[0,1,1] neg_lo:[1,0,0]
  v_cvt_pk_bf16_f32 v255, v172, v173
  v_pk_fma_f32 v[232:233], v[154:155], v[52:53], v[232:233] op_sel:[1,1,0] op_sel_hi:[0,1,1] neg_lo:[1,0,0]
  ds_write2_b32 v225, v254, v255 offset0:0 offset1:68
  v_pk_fma_f32 v[234:235], v[38:39], v[156:157], v[234:235] op_sel:[1,1,0] op_sel_hi:[0,1,1] neg_lo:[1,0,0]
  v_cvt_pk_bf16_f32 v248, v230, v231
  v_pk_fma_f32 v[236:237], v[56:57], v[156:157], v[236:237] op_sel:[1,1,0] op_sel_hi:[0,1,1] neg_lo:[1,0,0]
  v_cvt_pk_bf16_f32 v250, v232, v233
  v_pk_fma_f32 v[238:239], v[158:159], v[156:157], v[238:239] op_sel:[1,1,0] op_sel_hi:[0,1,1] neg_lo:[1,0,0]
  ds_write2_b32 v212, v248, v250 offset0:136 offset1:204
  v_pk_fma_f32 v[16:17], v[160:161], v[156:157], v[16:17] op_sel:[1,1,0] op_sel_hi:[0,1,1] neg_lo:[1,0,0]
  v_cvt_pk_bf16_f32 v253, v234, v235
  v_pk_fma_f32 v[32:33], v[56:57], v[152:153], v[32:33] op_sel:[1,1,0] op_sel_hi:[0,1,1] neg_lo:[1,0,0]
  v_cvt_pk_bf16_f32 v254, v236, v237
  v_pk_mul_f32 v[18:19], v[162:163], v[50:51] op_sel_hi:[1,0]
  ds_write2_b32 v218, v253, v254 offset0:0 offset1:68
  v_pk_mul_f32 v[22:23], v[164:165], v[50:51] op_sel_hi:[1,0]
  v_cvt_pk_bf16_f32 v255, v32, v33
  v_pk_mul_f32 v[26:27], v[166:167], v[50:51] op_sel_hi:[1,0]
  ds_write_b32 v3, v255 offset:2720
  v_pk_mul_f32 v[36:37], v[168:169], v[50:51] op_sel_hi:[1,0]
  v_cvt_pk_bf16_f32 v248, v238, v239
  v_pk_mul_f32 v[28:29], v[170:171], v[50:51] op_sel_hi:[1,0]
  v_cvt_pk_bf16_f32 v250, v16, v17
  v_pk_mul_f32 v[30:31], v[172:173], v[50:51] op_sel_hi:[1,0]
  ds_write2_b32 v218, v248, v250 offset0:136 offset1:204
  v_pk_mul_f32 v[40:41], v[174:175], v[50:51] op_sel_hi:[1,0]
  v_cvt_pk_bf16_f32 v253, v174, v175
  v_pk_mul_f32 v[42:43], v[228:229], v[50:51] op_sel_hi:[1,0]
  v_cvt_pk_bf16_f32 v254, v228, v229
  v_pk_mul_f32 v[44:45], v[38:39], v[152:153] op_sel_hi:[1,0]
  ds_write2_b32 v225, v253, v254 offset0:136 offset1:204
  v_pk_mul_f32 v[46:47], v[154:155], v[152:153] op_sel_hi:[1,0]
  v_pk_mul_f32 v[48:49], v[230:231], v[152:153] op_sel_hi:[1,0]
  v_pk_mul_f32 v[34:35], v[232:233], v[152:153] op_sel_hi:[1,0]
  v_pk_mul_f32 v[54:55], v[56:57], v[52:53] op_sel_hi:[1,0]
  v_pk_mul_f32 v[20:21], v[32:33], v[52:53] op_sel_hi:[1,0]
  v_pk_mul_f32 v[58:59], v[56:57], v[24:25] op_sel_hi:[1,0]
  v_pk_mul_f32 v[60:61], v[158:159], v[152:153] op_sel_hi:[1,0]
  v_pk_mul_f32 v[62:63], v[158:159], v[24:25] op_sel_hi:[1,0]
  v_pk_mul_f32 v[144:145], v[160:161], v[152:153] op_sel_hi:[1,0]
  v_pk_mul_f32 v[146:147], v[160:161], v[24:25] op_sel_hi:[1,0]
  v_pk_mul_f32 v[148:149], v[234:235], v[24:25] op_sel_hi:[1,0]
  v_pk_mul_f32 v[150:151], v[236:237], v[24:25] op_sel_hi:[1,0]
  v_pk_mul_f32 v[156:157], v[238:239], v[24:25] op_sel_hi:[1,0]
  v_pk_fma_f32 v[18:19], v[162:163], v[50:51], v[18:19] op_sel:[1,1,0] op_sel_hi:[0,1,1] neg_lo:[1,0,0]
  v_pk_mul_f32 v[162:163], v[16:17], v[24:25] op_sel_hi:[1,0]
  v_cvt_pk_bf16_f32 v248, v18, v19
  v_pk_fma_f32 v[22:23], v[164:165], v[50:51], v[22:23] op_sel:[1,1,0] op_sel_hi:[0,1,1] neg_lo:[1,0,0]
  v_pk_fma_f32 v[26:27], v[166:167], v[50:51], v[26:27] op_sel:[1,1,0] op_sel_hi:[0,1,1] neg_lo:[1,0,0]
  v_cvt_pk_bf16_f32 v250, v22, v23
  v_pk_fma_f32 v[36:37], v[168:169], v[50:51], v[36:37] op_sel:[1,1,0] op_sel_hi:[0,1,1] neg_lo:[1,0,0]
  ds_write2_b32 v226, v248, v250 offset0:0 offset1:68
  v_cvt_pk_bf16_f32 v253, v26, v27
  v_pk_fma_f32 v[28:29], v[170:171], v[50:51], v[28:29] op_sel:[1,1,0] op_sel_hi:[0,1,1] neg_lo:[1,0,0]
  v_cvt_pk_bf16_f32 v254, v36, v37
  v_pk_fma_f32 v[30:31], v[172:173], v[50:51], v[30:31] op_sel:[1,1,0] op_sel_hi:[0,1,1] neg_lo:[1,0,0]
  ds_write2_b32 v226, v253, v254 offset0:136 offset1:204
  v_pk_fma_f32 v[40:41], v[174:175], v[50:51], v[40:41] op_sel:[1,1,0] op_sel_hi:[0,1,1] neg_lo:[1,0,0]
  v_cvt_pk_bf16_f32 v248, v28, v29
  v_pk_fma_f32 v[42:43], v[228:229], v[50:51], v[42:43] op_sel:[1,1,0] op_sel_hi:[0,1,1] neg_lo:[1,0,0]
  v_cvt_pk_bf16_f32 v250, v30, v31
  v_pk_fma_f32 v[44:45], v[38:39], v[152:153], v[44:45] op_sel:[1,1,0] op_sel_hi:[0,1,1] neg_lo:[1,0,0]
  ds_write2_b32 v227, v248, v250 offset0:0 offset1:68
  v_pk_fma_f32 v[46:47], v[154:155], v[152:153], v[46:47] op_sel:[1,1,0] op_sel_hi:[0,1,1] neg_lo:[1,0,0]
  v_cvt_pk_bf16_f32 v253, v44, v45
  v_pk_fma_f32 v[48:49], v[230:231], v[152:153], v[48:49] op_sel:[1,1,0] op_sel_hi:[0,1,1] neg_lo:[1,0,0]
  v_cvt_pk_bf16_f32 v254, v46, v47
  v_pk_fma_f32 v[34:35], v[232:233], v[152:153], v[34:35] op_sel:[1,1,0] op_sel_hi:[0,1,1] neg_lo:[1,0,0]
  ds_write2_b32 v213, v253, v254 offset0:0 offset1:68
  v_pk_fma_f32 v[54:55], v[56:57], v[52:53], v[54:55] op_sel:[1,1,0] op_sel_hi:[0,1,1] neg_lo:[1,0,0]
  v_cvt_pk_bf16_f32 v248, v48, v49
  v_pk_fma_f32 v[20:21], v[32:33], v[52:53], v[20:21] op_sel:[1,1,0] op_sel_hi:[0,1,1] neg_lo:[1,0,0]
  v_cvt_pk_bf16_f32 v250, v34, v35
  v_pk_fma_f32 v[58:59], v[56:57], v[24:25], v[58:59] op_sel:[1,1,0] op_sel_hi:[0,1,1] neg_lo:[1,0,0]
  ds_write2_b32 v213, v248, v250 offset0:136 offset1:204
  v_pk_fma_f32 v[60:61], v[158:159], v[152:153], v[60:61] op_sel:[1,1,0] op_sel_hi:[0,1,1] neg_lo:[1,0,0]
  v_cvt_pk_bf16_f32 v253, v54, v55
  v_pk_fma_f32 v[62:63], v[158:159], v[24:25], v[62:63] op_sel:[1,1,0] op_sel_hi:[0,1,1] neg_lo:[1,0,0]
  ds_write2_b32 v214, v249, v253 offset0:0 offset1:68
  v_pk_fma_f32 v[144:145], v[160:161], v[152:153], v[144:145] op_sel:[1,1,0] op_sel_hi:[0,1,1] neg_lo:[1,0,0]
  v_cvt_pk_bf16_f32 v254, v20, v21
  v_pk_fma_f32 v[146:147], v[160:161], v[24:25], v[146:147] op_sel:[1,1,0] op_sel_hi:[0,1,1] neg_lo:[1,0,0]
  ds_write2_b32 v215, v255, v254 offset0:0 offset1:68
  v_pk_fma_f32 v[148:149], v[234:235], v[24:25], v[148:149] op_sel:[1,1,0] op_sel_hi:[0,1,1] neg_lo:[1,0,0]
  v_cvt_pk_bf16_f32 v248, v58, v59
  v_pk_fma_f32 v[150:151], v[236:237], v[24:25], v[150:151] op_sel:[1,1,0] op_sel_hi:[0,1,1] neg_lo:[1,0,0]
  ds_write_b32 v3, v248 offset:3808
  v_pk_fma_f32 v[156:157], v[238:239], v[24:25], v[156:157] op_sel:[1,1,0] op_sel_hi:[0,1,1] neg_lo:[1,0,0]
  v_cvt_pk_bf16_f32 v250, v60, v61
  v_pk_fma_f32 v[162:163], v[16:17], v[24:25], v[162:163] op_sel:[1,1,0] op_sel_hi:[0,1,1] neg_lo:[1,0,0]
  ds_write2_b32 v216, v251, v250 offset0:0 offset1:68
  v_cvt_pk_bf16_f32 v249, v144, v145
  v_cvt_pk_bf16_f32 v253, v62, v63
  ds_write2_b32 v216, v252, v249 offset0:136 offset1:204
  ds_write2_b32 v217, v250, v253 offset0:0 offset1:68
  v_cvt_pk_bf16_f32 v255, v146, v147
  v_cvt_pk_bf16_f32 v254, v148, v149
  ds_write2_b32 v217, v249, v255 offset0:136 offset1:204
  v_cvt_pk_bf16_f32 v248, v150, v151
  v_cvt_pk_bf16_f32 v251, v156, v157
  ds_write2_b32 v219, v254, v248 offset0:0 offset1:68
  v_cvt_pk_bf16_f32 v252, v162, v163
  v_cvt_pk_bf16_f32 v250, v40, v41
  ds_write2_b32 v219, v251, v252 offset0:136 offset1:204
  v_cvt_pk_bf16_f32 v253, v42, v43
  ds_write2_b32 v227, v250, v253 offset0:136 offset1:204
  ds_read_b128 v[64:67], v5 offset:0
  ds_read_b128 v[68:71], v5 offset:8704
  ds_read_b128 v[72:75], v5 offset:32
  ds_read_b128 v[76:79], v5 offset:8736
  ds_read_b128 v[80:83], v5 offset:64
  ds_read_b128 v[84:87], v5 offset:8768
  ds_read_b128 v[88:91], v5 offset:96
  ds_read_b128 v[92:95], v5 offset:8800
  ds_read_b128 v[96:99], v5 offset:128
  ds_read_b128 v[100:103], v5 offset:8832
  ds_read_b128 v[104:107], v5 offset:160
  ds_read_b128 v[108:111], v5 offset:8864
  ds_read_b128 v[112:115], v5 offset:192
  ds_read_b128 v[116:119], v5 offset:8896
  ds_read_b128 v[120:123], v5 offset:224
  ds_read_b128 v[124:127], v5 offset:8928
  s_cmp_eq_u32 s64, 0x07060c0c
  s_mov_b32 s64, 0x07060c0c
  s_cbranch_scc0 K_half
  s_waitcnt vmcnt(0)
  v_readlane_b32 s24, v176, 0
  v_readlane_b32 s25, v180, 0
  v_readlane_b32 s26, v184, 0
  v_readlane_b32 s27, v188, 0
  v_mov_b32 v16, 0
  v_mov_b32 v17, 0
  v_mov_b32 v18, 0
  v_mov_b32 v19, 0
  v_mov_b32 v20, 0
  v_mov_b32 v21, 0
  v_mov_b32 v22, 0
  v_mov_b32 v208, s25
  v_mov_b32 v209, s26
  v_mov_b32 v210, s27
  v_mov_b32 v211, 0
  s_waitcnt lgkmcnt(14)
  v_mfma_f32_32x32x16_bf16 v[128:143], v[64:67], v[68:71], v[128:143]
  s_lshl_b32 s24, s24, 16
  v_mov_b32 v23, s24
  v_cmp_eq_u32 vcc, 1, v1
  v_mov_b32_dpp v208, v176 wave_shl:1 row_mask:0xf bank_mask:0xf
  v_mov_b32_dpp v209, v180 wave_shl:1 row_mask:0xf bank_mask:0xf
  v_mov_b32_dpp v210, v184 wave_shl:1 row_mask:0xf bank_mask:0xf
  v_mov_b32_dpp v211, v188 wave_shl:1 row_mask:0xf bank_mask:0xf
  s_waitcnt lgkmcnt(12)
  v_mfma_f32_32x32x16_bf16 v[128:143], v[72:75], v[76:79], v[128:143]
  v_cndmask_b32 v23, 0, v23, vcc
  v_alignbit_b32 v192, v177, v176, 16
  v_alignbit_b32 v193, v178, v177, 16
  v_alignbit_b32 v194, v179, v178, 16
  v_alignbit_b32 v195, v208, v179, 16
  s_waitcnt lgkmcnt(10)
  v_mfma_f32_32x32x16_bf16 v[128:143], v[80:83], v[84:87], v[128:143]
  v_alignbit_b32 v196, v181, v180, 16
  v_alignbit_b32 v197, v182, v181, 16
  v_alignbit_b32 v198, v183, v182, 16
  v_alignbit_b32 v199, v209, v183, 16
  s_waitcnt lgkmcnt(8)
  v_mfma_f32_32x32x16_bf16 v[128:143], v[88:91], v[92:95], v[128:143]
  v_alignbit_b32 v200, v185, v184, 16
  v_alignbit_b32 v201, v186, v185, 16
  v_alignbit_b32 v202, v187, v186, 16
  v_alignbit_b32 v203, v210, v187, 16
  s_waitcnt lgkmcnt(6)
  v_mfma_f32_32x32x16_bf16 v[128:143], v[96:99], v[100:103], v[128:143]
  v_alignbit_b32 v204, v189, v188, 16
  v_alignbit_b32 v205, v190, v189, 16
  v_alignbit_b32 v206, v191, v190, 16
  v_alignbit_b32 v207, v211, v191, 16
  s_waitcnt lgkmcnt(4)
  v_mfma_f32_32x32x16_bf16 v[128:143], v[104:107], v[108:111], v[128:143]
  s_waitcnt lgkmcnt(2)
  v_mfma_f32_32x32x16_bf16 v[128:143], v[112:115], v[116:119], v[128:143]
  s_waitcnt lgkmcnt(0)
  v_mfma_f32_32x32x16_bf16 v[128:143], v[120:123], v[124:127], v[128:143]
  ds_write_b128 v246, v[176:179] offset:32
  ds_write_b128 v246, v[180:183] offset:1056
  ds_write_b128 v246, v[184:187] offset:2080
  ds_write_b128 v246, v[188:191] offset:3104
  ds_write_b128 v246, v[192:195] offset:5216
  ds_write_b128 v246, v[196:199] offset:6240
  ds_write_b128 v246, v[200:203] offset:7264
  ds_write_b128 v246, v[204:207] offset:8288
  s_mov_b64 exec, 3
  ds_write_b128 v246, v[16:19]
  ds_write_b128 v246, v[20:23] offset:5184
  s_mov_b32 exec_lo, -1
  ds_write_b128 v246, v[16:19] offset:14400
  s_mov_b64 exec, s[22:23]
  v_add_f32 v128, v128, v15
  v_mov_b32 v40, v140
  v_mov_b32 v41, v140
  v_mov_b32 v42, v141
  v_mov_b32 v43, v141
  v_mov_b32 v44, v142
  v_mov_b32 v45, v142
  v_mov_b32 v46, v143
  v_mov_b32 v47, v143
  v_cvt_pk_bf16_f32 v26, v131, v130
  v_cvt_pk_bf16_f32 v27, v129, v128
  v_cvt_pk_bf16_f32 v24, v134, v133
  v_cvt_pk_bf16_f32 v25, v132, v132
  v_permlane32_swap_b32 v40, v41
  v_permlane32_swap_b32 v42, v43
  v_permlane32_swap_b32 v44, v45
  v_permlane32_swap_b32 v46, v47
  v_cndmask_b32 v48, v136, v137, s[60:61]
  v_cndmask_b32 v49, v138, v139, s[60:61]
  v_permlane32_swap_b32 v26, v24
  v_permlane32_swap_b32 v27, v25
  ds_write_b128 v245, v[24:27] offset:3072
  v_cvt_pk_bf16_f32 v30, v137, v48
  v_cvt_pk_bf16_f32 v31, v136, v136
  v_cvt_pk_bf16_f32 v28, v139, v49
  v_cvt_pk_bf16_f32 v29, v138, v138
  v_cndmask_b32 v40, v40, v140, s[62:63]
  v_cndmask_b32 v42, v42, v141, s[62:63]
  v_cndmask_b32 v44, v44, v142, s[62:63]
  v_cndmask_b32 v46, v46, v143, s[62:63]
  v_permlane32_swap_b32 v30, v28
  v_permlane32_swap_b32 v31, v29
  ds_write_b128 v245, v[28:31] offset:2048
  v_cvt_pk_bf16_f32 v34, v140, v140
  v_cvt_pk_bf16_f32 v35, v140, v40
  v_cvt_pk_bf16_f32 v32, v141, v141
  v_cvt_pk_bf16_f32 v33, v141, v42
  s_nop 0
  v_permlane32_swap_b32 v34, v32
  v_permlane32_swap_b32 v35, v33
  ds_write_b128 v245, v[32:35] offset:1024
  v_cvt_pk_bf16_f32 v38, v142, v142
  v_cvt_pk_bf16_f32 v39, v142, v44
  v_cvt_pk_bf16_f32 v36, v143, v143
  v_cvt_pk_bf16_f32 v37, v143, v46
  s_nop 0
  v_permlane32_swap_b32 v38, v36
  v_permlane32_swap_b32 v39, v37
  ds_write_b128 v245, v[36:39] offset:0
  s_nop 1
  ds_read_b128 v[48:51], v244 offset:3584
  ds_read2_b32 v[16:17], v240 offset0:0 offset1:1
  ds_read2_b32 v[18:19], v240 offset0:2 offset1:3
  ds_read_b128 v[52:55], v244 offset:3072
  ds_read2_b32 v[20:21], v240 offset0:128 offset1:129
  ds_read2_b32 v[22:23], v240 offset0:130 offset1:131
  ds_read_b128 v[56:59], v244 offset:2560
  ds_read2_b32 v[24:25], v241 offset0:0 offset1:1
  ds_read2_b32 v[26:27], v241 offset0:2 offset1:3
  ds_read_b128 v[60:63], v244 offset:2048
  ds_read2_b32 v[28:29], v241 offset0:128 offset1:129
  ds_read2_b32 v[30:31], v241 offset0:130 offset1:131
  ds_read_b128 v[64:67], v244 offset:1536
  ds_read2_b32 v[32:33], v242 offset0:0 offset1:1
  ds_read2_b32 v[34:35], v242 offset0:2 offset1:3
  ds_read_b128 v[68:71], v244 offset:1024
  ds_read2_b32 v[36:37], v242 offset0:128 offset1:129
  ds_read2_b32 v[38:39], v242 offset0:130 offset1:131
  ds_read_b128 v[72:75], v244 offset:512
  ds_read2_b32 v[40:41], v243 offset0:0 offset1:1
  ds_read2_b32 v[42:43], v243 offset0:2 offset1:3
  ds_read_b128 v[76:79], v244 offset:0
  ds_read2_b32 v[44:45], v243 offset0:128 offset1:129
  ds_read2_b32 v[46:47], v243 offset0:130 offset1:131
  s_waitcnt lgkmcnt(15)
  v_mfma_f32_16x16x32_bf16 v[144:147], v[16:19], v[48:51], 0
  s_waitcnt lgkmcnt(15)
  v_mfma_f32_16x16x32_bf16 v[148:151], v[16:19], v[52:55], 0
  v_mfma_f32_16x16x32_bf16 v[148:151], v[20:23], v[48:51], v[148:151]
  v_mfma_f32_16x16x32_bf16 v[152:155], v[20:23], v[52:55], 0
  s_waitcnt lgkmcnt(15)
  v_mfma_f32_16x16x32_bf16 v[152:155], v[16:19], v[56:59], v[152:155]
  v_mfma_f32_16x16x32_bf16 v[156:159], v[20:23], v[56:59], 0
  v_mfma_f32_16x16x32_bf16 v[152:155], v[24:27], v[48:51], v[152:155]
  v_mfma_f32_16x16x32_bf16 v[156:159], v[24:27], v[52:55], v[156:159]
  v_mfma_f32_16x16x32_bf16 v[160:163], v[24:27], v[56:59], 0
  s_waitcnt lgkmcnt(0)
  v_mfma_f32_16x16x32_bf16 v[156:159], v[16:19], v[60:63], v[156:159]
  ds_read_b128 v[112:115], v244 offset:3648
  v_mfma_f32_16x16x32_bf16 v[160:163], v[20:23], v[60:63], v[160:163]
  ds_read2_b32 v[80:81], v240 offset0:16 offset1:17
  v_mfma_f32_16x16x32_bf16 v[164:167], v[24:27], v[60:63], 0
  ds_read2_b32 v[82:83], v240 offset0:18 offset1:19
  v_mfma_f32_16x16x32_bf16 v[156:159], v[28:31], v[48:51], v[156:159]
  ds_read_b128 v[116:119], v244 offset:3136
  v_mfma_f32_16x16x32_bf16 v[160:163], v[28:31], v[52:55], v[160:163]
  ds_read2_b32 v[84:85], v240 offset0:144 offset1:145
  v_mfma_f32_16x16x32_bf16 v[164:167], v[28:31], v[56:59], v[164:167]
  ds_read2_b32 v[86:87], v240 offset0:146 offset1:147
  v_mfma_f32_16x16x32_bf16 v[168:171], v[28:31], v[60:63], 0
  ds_read_b128 v[120:123], v244 offset:2624
  v_mfma_f32_16x16x32_bf16 v[160:163], v[16:19], v[64:67], v[160:163]
  ds_read2_b32 v[88:89], v241 offset0:16 offset1:17
  v_mfma_f32_16x16x32_bf16 v[164:167], v[20:23], v[64:67], v[164:167]
  ds_read2_b32 v[90:91], v241 offset0:18 offset1:19
  v_mfma_f32_16x16x32_bf16 v[168:171], v[24:27], v[64:67], v[168:171]
  ds_read_b128 v[124:127], v244 offset:2112
  v_mfma_f32_16x16x32_bf16 v[172:175], v[28:31], v[64:67], 0
  ds_read2_b32 v[92:93], v241 offset0:144 offset1:145
  v_mfma_f32_16x16x32_bf16 v[160:163], v[32:35], v[48:51], v[160:163]
  ds_read2_b32 v[94:95], v241 offset0:146 offset1:147
  v_mfma_f32_16x16x32_bf16 v[164:167], v[32:35], v[52:55], v[164:167]
  ds_read_b128 v[128:131], v244 offset:1600
  v_mfma_f32_16x16x32_bf16 v[168:171], v[32:35], v[56:59], v[168:171]
  ds_read2_b32 v[96:97], v242 offset0:16 offset1:17
  v_mfma_f32_16x16x32_bf16 v[172:175], v[32:35], v[60:63], v[172:175]
  ds_read2_b32 v[98:99], v242 offset0:18 offset1:19
  v_mfma_f32_16x16x32_bf16 v[164:167], v[16:19], v[68:71], v[164:167]
  ds_read_b128 v[132:135], v244 offset:1088
  v_mfma_f32_16x16x32_bf16 v[168:171], v[20:23], v[68:71], v[168:171]
  ds_read2_b32 v[100:101], v242 offset0:144 offset1:145
  v_mfma_f32_16x16x32_bf16 v[172:175], v[24:27], v[68:71], v[172:175]
  ds_read2_b32 v[102:103], v242 offset0:146 offset1:147
  v_mfma_f32_16x16x32_bf16 v[164:167], v[36:39], v[48:51], v[164:167]
  ds_read_b128 v[136:139], v244 offset:576
  v_mfma_f32_16x16x32_bf16 v[168:171], v[36:39], v[52:55], v[168:171]
  ds_read2_b32 v[104:105], v243 offset0:16 offset1:17
  v_mfma_f32_16x16x32_bf16 v[172:175], v[36:39], v[56:59], v[172:175]
  ds_read2_b32 v[106:107], v243 offset0:18 offset1:19
  v_mfma_f32_16x16x32_bf16 v[168:171], v[16:19], v[72:75], v[168:171]
  ds_read_b128 v[140:143], v244 offset:64
  v_mfma_f32_16x16x32_bf16 v[172:175], v[20:23], v[72:75], v[172:175]
  ds_read2_b32 v[108:109], v243 offset0:144 offset1:145
  v_mfma_f32_16x16x32_bf16 v[168:171], v[40:43], v[48:51], v[168:171]
  ds_read2_b32 v[110:111], v243 offset0:146 offset1:147
  v_mfma_f32_16x16x32_bf16 v[172:175], v[40:43], v[52:55], v[172:175]
  v_mfma_f32_16x16x32_bf16 v[172:175], v[16:19], v[76:79], v[172:175]
  v_mfma_f32_16x16x32_bf16 v[172:175], v[44:47], v[48:51], v[172:175]
  s_waitcnt lgkmcnt(0)
  v_mfma_f32_16x16x32_bf16 v[144:147], v[80:83], v[112:115], v[144:147]
  ds_read_b128 v[48:51], v244 offset:3712
  v_mfma_f32_16x16x32_bf16 v[148:151], v[80:83], v[116:119], v[148:151]
  ds_read2_b32 v[16:17], v240 offset0:32 offset1:33
  v_mfma_f32_16x16x32_bf16 v[148:151], v[84:87], v[112:115], v[148:151]
  ds_read2_b32 v[18:19], v240 offset0:34 offset1:35
  v_mfma_f32_16x16x32_bf16 v[152:155], v[84:87], v[116:119], v[152:155]
  ds_read_b128 v[52:55], v244 offset:3200
  v_mfma_f32_16x16x32_bf16 v[152:155], v[80:83], v[120:123], v[152:155]
  ds_read2_b32 v[20:21], v240 offset0:160 offset1:161
  v_mfma_f32_16x16x32_bf16 v[156:159], v[84:87], v[120:123], v[156:159]
  ds_read2_b32 v[22:23], v240 offset0:162 offset1:163
  v_mfma_f32_16x16x32_bf16 v[152:155], v[88:91], v[112:115], v[152:155]
  ds_read_b128 v[56:59], v244 offset:2688
  v_mfma_f32_16x16x32_bf16 v[156:159], v[88:91], v[116:119], v[156:159]
  ds_read2_b32 v[24:25], v241 offset0:32 offset1:33
  v_mfma_f32_16x16x32_bf16 v[160:163], v[88:91], v[120:123], v[160:163]
  ds_read2_b32 v[26:27], v241 offset0:34 offset1:35
  v_mfma_f32_16x16x32_bf16 v[156:159], v[80:83], v[124:127], v[156:159]
  ds_read_b128 v[60:63], v244 offset:2176
  v_mfma_f32_16x16x32_bf16 v[160:163], v[84:87], v[124:127], v[160:163]
  ds_read2_b32 v[28:29], v241 offset0:160 offset1:161
  v_mfma_f32_16x16x32_bf16 v[164:167], v[88:91], v[124:127], v[164:167]
  ds_read2_b32 v[30:31], v241 offset0:162 offset1:163
  v_mfma_f32_16x16x32_bf16 v[156:159], v[92:95], v[112:115], v[156:159]
  ds_read_b128 v[64:67], v244 offset:1664
  v_mfma_f32_16x16x32_bf16 v[160:163], v[92:95], v[116:119], v[160:163]
  ds_read2_b32 v[32:33], v242 offset0:32 offset1:33
  v_mfma_f32_16x16x32_bf16 v[164:167], v[92:95], v[120:123], v[164:167]
  ds_read2_b32 v[34:35], v242 offset0:34 offset1:35
  v_mfma_f32_16x16x32_bf16 v[168:171], v[92:95], v[124:127], v[168:171]
  ds_read_b128 v[68:71], v244 offset:1152
  v_mfma_f32_16x16x32_bf16 v[160:163], v[80:83], v[128:131], v[160:163]
  ds_read2_b32 v[36:37], v242 offset0:160 offset1:161
  v_mfma_f32_16x16x32_bf16 v[164:167], v[84:87], v[128:131], v[164:167]
  ds_read2_b32 v[38:39], v242 offset0:162 offset1:163
  v_mfma_f32_16x16x32_bf16 v[168:171], v[88:91], v[128:131], v[168:171]
  ds_read_b128 v[72:75], v244 offset:640
  v_mfma_f32_16x16x32_bf16 v[172:175], v[92:95], v[128:131], v[172:175]
  ds_read2_b32 v[40:41], v243 offset0:32 offset1:33
  v_mfma_f32_16x16x32_bf16 v[160:163], v[96:99], v[112:115], v[160:163]
  ds_read2_b32 v[42:43], v243 offset0:34 offset1:35
  v_mfma_f32_16x16x32_bf16 v[164:167], v[96:99], v[116:119], v[164:167]
  ds_read_b128 v[76:79], v244 offset:128
  v_mfma_f32_16x16x32_bf16 v[168:171], v[96:99], v[120:123], v[168:171]
  ds_read2_b32 v[44:45], v243 offset0:160 offset1:161
  v_mfma_f32_16x16x32_bf16 v[172:175], v[96:99], v[124:127], v[172:175]
  ds_read2_b32 v[46:47], v243 offset0:162 offset1:163
  v_mfma_f32_16x16x32_bf16 v[164:167], v[80:83], v[132:135], v[164:167]
  v_mfma_f32_16x16x32_bf16 v[168:171], v[84:87], v[132:135], v[168:171]
  v_mfma_f32_16x16x32_bf16 v[172:175], v[88:91], v[132:135], v[172:175]
  v_mfma_f32_16x16x32_bf16 v[164:167], v[100:103], v[112:115], v[164:167]
  v_mfma_f32_16x16x32_bf16 v[168:171], v[100:103], v[116:119], v[168:171]
  v_mfma_f32_16x16x32_bf16 v[172:175], v[100:103], v[120:123], v[172:175]
  v_mfma_f32_16x16x32_bf16 v[168:171], v[80:83], v[136:139], v[168:171]
  v_mfma_f32_16x16x32_bf16 v[172:175], v[84:87], v[136:139], v[172:175]
  v_mfma_f32_16x16x32_bf16 v[168:171], v[104:107], v[112:115], v[168:171]
  v_mfma_f32_16x16x32_bf16 v[172:175], v[104:107], v[116:119], v[172:175]
  v_mfma_f32_16x16x32_bf16 v[172:175], v[80:83], v[140:143], v[172:175]
  v_mfma_f32_16x16x32_bf16 v[172:175], v[108:111], v[112:115], v[172:175]
  s_waitcnt lgkmcnt(0)
  v_mfma_f32_16x16x32_bf16 v[144:147], v[16:19], v[48:51], v[144:147]
  ds_read_b128 v[112:115], v244 offset:3776
  v_mfma_f32_16x16x32_bf16 v[148:151], v[16:19], v[52:55], v[148:151]
  ds_read2_b32 v[80:81], v240 offset0:48 offset1:49
  v_mfma_f32_16x16x32_bf16 v[148:151], v[20:23], v[48:51], v[148:151]
  ds_read2_b32 v[82:83], v240 offset0:50 offset1:51
  v_mfma_f32_16x16x32_bf16 v[152:155], v[20:23], v[52:55], v[152:155]
  ds_read_b128 v[116:119], v244 offset:3264
  v_mfma_f32_16x16x32_bf16 v[152:155], v[16:19], v[56:59], v[152:155]
  ds_read2_b32 v[84:85], v240 offset0:176 offset1:177
  v_mfma_f32_16x16x32_bf16 v[156:159], v[20:23], v[56:59], v[156:159]
  ds_read2_b32 v[86:87], v240 offset0:178 offset1:179
  v_mfma_f32_16x16x32_bf16 v[152:155], v[24:27], v[48:51], v[152:155]
  ds_read_b128 v[120:123], v244 offset:2752
  v_mfma_f32_16x16x32_bf16 v[156:159], v[24:27], v[52:55], v[156:159]
  ds_read2_b32 v[88:89], v241 offset0:48 offset1:49
  v_mfma_f32_16x16x32_bf16 v[160:163], v[24:27], v[56:59], v[160:163]
  ds_read2_b32 v[90:91], v241 offset0:50 offset1:51
  v_mfma_f32_16x16x32_bf16 v[156:159], v[16:19], v[60:63], v[156:159]
  ds_read_b128 v[124:127], v244 offset:2240
  v_mfma_f32_16x16x32_bf16 v[160:163], v[20:23], v[60:63], v[160:163]
  ds_read2_b32 v[92:93], v241 offset0:176 offset1:177
  v_mfma_f32_16x16x32_bf16 v[164:167], v[24:27], v[60:63], v[164:167]
  ds_read2_b32 v[94:95], v241 offset0:178 offset1:179
  v_mfma_f32_16x16x32_bf16 v[156:159], v[28:31], v[48:51], v[156:159]
  ds_read_b128 v[128:131], v244 offset:1728
  v_mfma_f32_16x16x32_bf16 v[160:163], v[28:31], v[52:55], v[160:163]
  ds_read2_b32 v[96:97], v242 offset0:48 offset1:49
  v_mfma_f32_16x16x32_bf16 v[164:167], v[28:31], v[56:59], v[164:167]
  ds_read2_b32 v[98:99], v242 offset0:50 offset1:51
  v_mfma_f32_16x16x32_bf16 v[168:171], v[28:31], v[60:63], v[168:171]
  ds_read_b128 v[132:135], v244 offset:1216
  v_mfma_f32_16x16x32_bf16 v[160:163], v[16:19], v[64:67], v[160:163]
  ds_read2_b32 v[100:101], v242 offset0:176 offset1:177
  v_mfma_f32_16x16x32_bf16 v[164:167], v[20:23], v[64:67], v[164:167]
  ds_read2_b32 v[102:103], v242 offset0:178 offset1:179
  v_mfma_f32_16x16x32_bf16 v[168:171], v[24:27], v[64:67], v[168:171]
  ds_read_b128 v[136:139], v244 offset:704
  v_mfma_f32_16x16x32_bf16 v[172:175], v[28:31], v[64:67], v[172:175]
  ds_read2_b32 v[104:105], v243 offset0:48 offset1:49
  v_mfma_f32_16x16x32_bf16 v[160:163], v[32:35], v[48:51], v[160:163]
  ds_read2_b32 v[106:107], v243 offset0:50 offset1:51
  v_mfma_f32_16x16x32_bf16 v[164:167], v[32:35], v[52:55], v[164:167]
  ds_read_b128 v[140:143], v244 offset:192
  v_mfma_f32_16x16x32_bf16 v[168:171], v[32:35], v[56:59], v[168:171]
  ds_read2_b32 v[108:109], v243 offset0:176 offset1:177
  v_mfma_f32_16x16x32_bf16 v[172:175], v[32:35], v[60:63], v[172:175]
  ds_read2_b32 v[110:111], v243 offset0:178 offset1:179
  v_mfma_f32_16x16x32_bf16 v[164:167], v[16:19], v[68:71], v[164:167]
  v_mfma_f32_16x16x32_bf16 v[168:171], v[20:23], v[68:71], v[168:171]
  v_mfma_f32_16x16x32_bf16 v[172:175], v[24:27], v[68:71], v[172:175]
  v_mfma_f32_16x16x32_bf16 v[164:167], v[36:39], v[48:51], v[164:167]
  v_mfma_f32_16x16x32_bf16 v[168:171], v[36:39], v[52:55], v[168:171]
  v_mfma_f32_16x16x32_bf16 v[172:175], v[36:39], v[56:59], v[172:175]
  v_mfma_f32_16x16x32_bf16 v[168:171], v[16:19], v[72:75], v[168:171]
  v_mfma_f32_16x16x32_bf16 v[172:175], v[20:23], v[72:75], v[172:175]
  v_mfma_f32_16x16x32_bf16 v[168:171], v[40:43], v[48:51], v[168:171]
  v_mfma_f32_16x16x32_bf16 v[172:175], v[40:43], v[52:55], v[172:175]
  v_mfma_f32_16x16x32_bf16 v[172:175], v[16:19], v[76:79], v[172:175]
  v_mfma_f32_16x16x32_bf16 v[172:175], v[44:47], v[48:51], v[172:175]
  s_waitcnt lgkmcnt(0)
  v_mfma_f32_16x16x32_bf16 v[144:147], v[80:83], v[112:115], v[144:147]
  ds_read_b128 v[48:51], v244 offset:3840
  v_mfma_f32_16x16x32_bf16 v[148:151], v[80:83], v[116:119], v[148:151]
  ds_read2_b32 v[16:17], v240 offset0:64 offset1:65
  v_mfma_f32_16x16x32_bf16 v[148:151], v[84:87], v[112:115], v[148:151]
  ds_read2_b32 v[18:19], v240 offset0:66 offset1:67
  v_mfma_f32_16x16x32_bf16 v[152:155], v[84:87], v[116:119], v[152:155]
  ds_read_b128 v[52:55], v244 offset:3328
  v_mfma_f32_16x16x32_bf16 v[152:155], v[80:83], v[120:123], v[152:155]
  ds_read2_b32 v[20:21], v240 offset0:192 offset1:193
  v_mfma_f32_16x16x32_bf16 v[156:159], v[84:87], v[120:123], v[156:159]
  ds_read2_b32 v[22:23], v240 offset0:194 offset1:195
  v_mfma_f32_16x16x32_bf16 v[152:155], v[88:91], v[112:115], v[152:155]
  ds_read_b128 v[56:59], v244 offset:2816
  v_mfma_f32_16x16x32_bf16 v[156:159], v[88:91], v[116:119], v[156:159]
  ds_read2_b32 v[24:25], v241 offset0:64 offset1:65
  v_mfma_f32_16x16x32_bf16 v[160:163], v[88:91], v[120:123], v[160:163]
  ds_read2_b32 v[26:27], v241 offset0:66 offset1:67
  v_mfma_f32_16x16x32_bf16 v[156:159], v[80:83], v[124:127], v[156:159]
  ds_read_b128 v[60:63], v244 offset:2304
  v_mfma_f32_16x16x32_bf16 v[160:163], v[84:87], v[124:127], v[160:163]
  ds_read2_b32 v[28:29], v241 offset0:192 offset1:193
  v_mfma_f32_16x16x32_bf16 v[164:167], v[88:91], v[124:127], v[164:167]
  ds_read2_b32 v[30:31], v241 offset0:194 offset1:195
  v_mfma_f32_16x16x32_bf16 v[156:159], v[92:95], v[112:115], v[156:159]
  ds_read_b128 v[64:67], v244 offset:1792
  v_mfma_f32_16x16x32_bf16 v[160:163], v[92:95], v[116:119], v[160:163]
  ds_read2_b32 v[32:33], v242 offset0:64 offset1:65
  v_mfma_f32_16x16x32_bf16 v[164:167], v[92:95], v[120:123], v[164:167]
  ds_read2_b32 v[34:35], v242 offset0:66 offset1:67
  v_mfma_f32_16x16x32_bf16 v[168:171], v[92:95], v[124:127], v[168:171]
  ds_read_b128 v[68:71], v244 offset:1280
  v_mfma_f32_16x16x32_bf16 v[160:163], v[80:83], v[128:131], v[160:163]
  ds_read2_b32 v[36:37], v242 offset0:192 offset1:193
  v_mfma_f32_16x16x32_bf16 v[164:167], v[84:87], v[128:131], v[164:167]
  ds_read2_b32 v[38:39], v242 offset0:194 offset1:195
  v_mfma_f32_16x16x32_bf16 v[168:171], v[88:91], v[128:131], v[168:171]
  ds_read_b128 v[72:75], v244 offset:768
  v_mfma_f32_16x16x32_bf16 v[172:175], v[92:95], v[128:131], v[172:175]
  ds_read2_b32 v[40:41], v243 offset0:64 offset1:65
  v_mfma_f32_16x16x32_bf16 v[160:163], v[96:99], v[112:115], v[160:163]
  ds_read2_b32 v[42:43], v243 offset0:66 offset1:67
  v_mfma_f32_16x16x32_bf16 v[164:167], v[96:99], v[116:119], v[164:167]
  ds_read_b128 v[76:79], v244 offset:256
  v_mfma_f32_16x16x32_bf16 v[168:171], v[96:99], v[120:123], v[168:171]
  ds_read2_b32 v[44:45], v243 offset0:192 offset1:193
  v_mfma_f32_16x16x32_bf16 v[172:175], v[96:99], v[124:127], v[172:175]
  ds_read2_b32 v[46:47], v243 offset0:194 offset1:195
  v_mfma_f32_16x16x32_bf16 v[164:167], v[80:83], v[132:135], v[164:167]
  v_mfma_f32_16x16x32_bf16 v[168:171], v[84:87], v[132:135], v[168:171]
  v_mfma_f32_16x16x32_bf16 v[172:175], v[88:91], v[132:135], v[172:175]
  v_mfma_f32_16x16x32_bf16 v[164:167], v[100:103], v[112:115], v[164:167]
  v_mfma_f32_16x16x32_bf16 v[168:171], v[100:103], v[116:119], v[168:171]
  v_mfma_f32_16x16x32_bf16 v[172:175], v[100:103], v[120:123], v[172:175]
  v_mfma_f32_16x16x32_bf16 v[168:171], v[80:83], v[136:139], v[168:171]
  v_mfma_f32_16x16x32_bf16 v[172:175], v[84:87], v[136:139], v[172:175]
  v_mfma_f32_16x16x32_bf16 v[168:171], v[104:107], v[112:115], v[168:171]
  v_mfma_f32_16x16x32_bf16 v[172:175], v[104:107], v[116:119], v[172:175]
  v_mfma_f32_16x16x32_bf16 v[172:175], v[80:83], v[140:143], v[172:175]
  v_mfma_f32_16x16x32_bf16 v[172:175], v[108:111], v[112:115], v[172:175]
  s_waitcnt lgkmcnt(0)
  v_mfma_f32_16x16x32_bf16 v[144:147], v[16:19], v[48:51], v[144:147]
  ds_read_b128 v[112:115], v244 offset:3904
  v_mfma_f32_16x16x32_bf16 v[148:151], v[16:19], v[52:55], v[148:151]
  ds_read2_b32 v[80:81], v240 offset0:80 offset1:81
  v_mfma_f32_16x16x32_bf16 v[148:151], v[20:23], v[48:51], v[148:151]
  ds_read2_b32 v[82:83], v240 offset0:82 offset1:83
  v_mfma_f32_16x16x32_bf16 v[152:155], v[20:23], v[52:55], v[152:155]
  ds_read_b128 v[116:119], v244 offset:3392
  v_mfma_f32_16x16x32_bf16 v[152:155], v[16:19], v[56:59], v[152:155]
  ds_read2_b32 v[84:85], v240 offset0:208 offset1:209
  v_mfma_f32_16x16x32_bf16 v[156:159], v[20:23], v[56:59], v[156:159]
  ds_read2_b32 v[86:87], v240 offset0:210 offset1:211
  v_mfma_f32_16x16x32_bf16 v[152:155], v[24:27], v[48:51], v[152:155]
  ds_read_b128 v[120:123], v244 offset:2880
  v_mfma_f32_16x16x32_bf16 v[156:159], v[24:27], v[52:55], v[156:159]
  ds_read2_b32 v[88:89], v241 offset0:80 offset1:81
  v_mfma_f32_16x16x32_bf16 v[160:163], v[24:27], v[56:59], v[160:163]
  ds_read2_b32 v[90:91], v241 offset0:82 offset1:83
  v_mfma_f32_16x16x32_bf16 v[156:159], v[16:19], v[60:63], v[156:159]
  ds_read_b128 v[124:127], v244 offset:2368
  v_mfma_f32_16x16x32_bf16 v[160:163], v[20:23], v[60:63], v[160:163]
  ds_read2_b32 v[92:93], v241 offset0:208 offset1:209
  v_mfma_f32_16x16x32_bf16 v[164:167], v[24:27], v[60:63], v[164:167]
  ds_read2_b32 v[94:95], v241 offset0:210 offset1:211
  v_mfma_f32_16x16x32_bf16 v[156:159], v[28:31], v[48:51], v[156:159]
  ds_read_b128 v[128:131], v244 offset:1856
  v_mfma_f32_16x16x32_bf16 v[160:163], v[28:31], v[52:55], v[160:163]
  ds_read2_b32 v[96:97], v242 offset0:80 offset1:81
  v_mfma_f32_16x16x32_bf16 v[164:167], v[28:31], v[56:59], v[164:167]
  ds_read2_b32 v[98:99], v242 offset0:82 offset1:83
  v_mfma_f32_16x16x32_bf16 v[168:171], v[28:31], v[60:63], v[168:171]
  ds_read_b128 v[132:135], v244 offset:1344
  v_mfma_f32_16x16x32_bf16 v[160:163], v[16:19], v[64:67], v[160:163]
  ds_read2_b32 v[100:101], v242 offset0:208 offset1:209
  v_mfma_f32_16x16x32_bf16 v[164:167], v[20:23], v[64:67], v[164:167]
  ds_read2_b32 v[102:103], v242 offset0:210 offset1:211
  v_mfma_f32_16x16x32_bf16 v[168:171], v[24:27], v[64:67], v[168:171]
  ds_read_b128 v[136:139], v244 offset:832
  v_mfma_f32_16x16x32_bf16 v[172:175], v[28:31], v[64:67], v[172:175]
  ds_read2_b32 v[104:105], v243 offset0:80 offset1:81
  v_mfma_f32_16x16x32_bf16 v[160:163], v[32:35], v[48:51], v[160:163]
  ds_read2_b32 v[106:107], v243 offset0:82 offset1:83
  v_mfma_f32_16x16x32_bf16 v[164:167], v[32:35], v[52:55], v[164:167]
  ds_read_b128 v[140:143], v244 offset:320
  v_mfma_f32_16x16x32_bf16 v[168:171], v[32:35], v[56:59], v[168:171]
  ds_read2_b32 v[108:109], v243 offset0:208 offset1:209
  v_mfma_f32_16x16x32_bf16 v[172:175], v[32:35], v[60:63], v[172:175]
  ds_read2_b32 v[110:111], v243 offset0:210 offset1:211
  v_mfma_f32_16x16x32_bf16 v[164:167], v[16:19], v[68:71], v[164:167]
  v_mfma_f32_16x16x32_bf16 v[168:171], v[20:23], v[68:71], v[168:171]
  v_mfma_f32_16x16x32_bf16 v[172:175], v[24:27], v[68:71], v[172:175]
  v_mfma_f32_16x16x32_bf16 v[164:167], v[36:39], v[48:51], v[164:167]
  v_mfma_f32_16x16x32_bf16 v[168:171], v[36:39], v[52:55], v[168:171]
  v_mfma_f32_16x16x32_bf16 v[172:175], v[36:39], v[56:59], v[172:175]
  v_mfma_f32_16x16x32_bf16 v[168:171], v[16:19], v[72:75], v[168:171]
  v_mfma_f32_16x16x32_bf16 v[172:175], v[20:23], v[72:75], v[172:175]
  v_mfma_f32_16x16x32_bf16 v[168:171], v[40:43], v[48:51], v[168:171]
  v_mfma_f32_16x16x32_bf16 v[172:175], v[40:43], v[52:55], v[172:175]
  v_mfma_f32_16x16x32_bf16 v[172:175], v[16:19], v[76:79], v[172:175]
  v_mfma_f32_16x16x32_bf16 v[172:175], v[44:47], v[48:51], v[172:175]
  s_waitcnt lgkmcnt(0)
  v_mfma_f32_16x16x32_bf16 v[144:147], v[80:83], v[112:115], v[144:147]
  ds_read_b128 v[48:51], v244 offset:3968
  v_mfma_f32_16x16x32_bf16 v[148:151], v[80:83], v[116:119], v[148:151]
  ds_read2_b32 v[16:17], v240 offset0:96 offset1:97
  v_mfma_f32_16x16x32_bf16 v[148:151], v[84:87], v[112:115], v[148:151]
  ds_read2_b32 v[18:19], v240 offset0:98 offset1:99
  v_mfma_f32_16x16x32_bf16 v[152:155], v[84:87], v[116:119], v[152:155]
  ds_read_b128 v[52:55], v244 offset:3456
  v_mfma_f32_16x16x32_bf16 v[152:155], v[80:83], v[120:123], v[152:155]
  ds_read2_b32 v[20:21], v240 offset0:224 offset1:225
  v_mfma_f32_16x16x32_bf16 v[156:159], v[84:87], v[120:123], v[156:159]
  ds_read2_b32 v[22:23], v240 offset0:226 offset1:227
  v_mfma_f32_16x16x32_bf16 v[152:155], v[88:91], v[112:115], v[152:155]
  ds_read_b128 v[56:59], v244 offset:2944
  v_mfma_f32_16x16x32_bf16 v[156:159], v[88:91], v[116:119], v[156:159]
  ds_read2_b32 v[24:25], v241 offset0:96 offset1:97
  v_mfma_f32_16x16x32_bf16 v[160:163], v[88:91], v[120:123], v[160:163]
  ds_read2_b32 v[26:27], v241 offset0:98 offset1:99
  v_mfma_f32_16x16x32_bf16 v[156:159], v[80:83], v[124:127], v[156:159]
  ds_read_b128 v[60:63], v244 offset:2432
  v_mfma_f32_16x16x32_bf16 v[160:163], v[84:87], v[124:127], v[160:163]
  ds_read2_b32 v[28:29], v241 offset0:224 offset1:225
  v_mfma_f32_16x16x32_bf16 v[164:167], v[88:91], v[124:127], v[164:167]
  ds_read2_b32 v[30:31], v241 offset0:226 offset1:227
  v_mfma_f32_16x16x32_bf16 v[156:159], v[92:95], v[112:115], v[156:159]
  ds_read_b128 v[64:67], v244 offset:1920
  v_mfma_f32_16x16x32_bf16 v[160:163], v[92:95], v[116:119], v[160:163]
  ds_read2_b32 v[32:33], v242 offset0:96 offset1:97
  v_mfma_f32_16x16x32_bf16 v[164:167], v[92:95], v[120:123], v[164:167]
  ds_read2_b32 v[34:35], v242 offset0:98 offset1:99
  v_mfma_f32_16x16x32_bf16 v[168:171], v[92:95], v[124:127], v[168:171]
  ds_read_b128 v[68:71], v244 offset:1408
  v_mfma_f32_16x16x32_bf16 v[160:163], v[80:83], v[128:131], v[160:163]
  ds_read2_b32 v[36:37], v242 offset0:224 offset1:225
  v_mfma_f32_16x16x32_bf16 v[164:167], v[84:87], v[128:131], v[164:167]
  ds_read2_b32 v[38:39], v242 offset0:226 offset1:227
  v_mfma_f32_16x16x32_bf16 v[168:171], v[88:91], v[128:131], v[168:171]
  ds_read_b128 v[72:75], v244 offset:896
  v_mfma_f32_16x16x32_bf16 v[172:175], v[92:95], v[128:131], v[172:175]
  ds_read2_b32 v[40:41], v243 offset0:96 offset1:97
  v_mfma_f32_16x16x32_bf16 v[160:163], v[96:99], v[112:115], v[160:163]
  ds_read2_b32 v[42:43], v243 offset0:98 offset1:99
  v_mfma_f32_16x16x32_bf16 v[164:167], v[96:99], v[116:119], v[164:167]
  ds_read_b128 v[76:79], v244 offset:384
  v_mfma_f32_16x16x32_bf16 v[168:171], v[96:99], v[120:123], v[168:171]
  ds_read2_b32 v[44:45], v243 offset0:224 offset1:225
  v_mfma_f32_16x16x32_bf16 v[172:175], v[96:99], v[124:127], v[172:175]
  ds_read2_b32 v[46:47], v243 offset0:226 offset1:227
  v_mfma_f32_16x16x32_bf16 v[164:167], v[80:83], v[132:135], v[164:167]
  v_mfma_f32_16x16x32_bf16 v[168:171], v[84:87], v[132:135], v[168:171]
  v_mfma_f32_16x16x32_bf16 v[172:175], v[88:91], v[132:135], v[172:175]
  v_mfma_f32_16x16x32_bf16 v[164:167], v[100:103], v[112:115], v[164:167]
  v_mfma_f32_16x16x32_bf16 v[168:171], v[100:103], v[116:119], v[168:171]
  v_mfma_f32_16x16x32_bf16 v[172:175], v[100:103], v[120:123], v[172:175]
  v_mfma_f32_16x16x32_bf16 v[168:171], v[80:83], v[136:139], v[168:171]
  v_mfma_f32_16x16x32_bf16 v[172:175], v[84:87], v[136:139], v[172:175]
  v_mfma_f32_16x16x32_bf16 v[168:171], v[104:107], v[112:115], v[168:171]
  v_mfma_f32_16x16x32_bf16 v[172:175], v[104:107], v[116:119], v[172:175]
  v_mfma_f32_16x16x32_bf16 v[172:175], v[80:83], v[140:143], v[172:175]
  v_mfma_f32_16x16x32_bf16 v[172:175], v[108:111], v[112:115], v[172:175]
  s_waitcnt lgkmcnt(0)
  v_mfma_f32_16x16x32_bf16 v[144:147], v[16:19], v[48:51], v[144:147]
  ds_read_b128 v[112:115], v244 offset:4032
  v_mfma_f32_16x16x32_bf16 v[148:151], v[16:19], v[52:55], v[148:151]
  ds_read2_b32 v[80:81], v240 offset0:112 offset1:113
  v_mfma_f32_16x16x32_bf16 v[148:151], v[20:23], v[48:51], v[148:151]
  ds_read2_b32 v[82:83], v240 offset0:114 offset1:115
  v_mfma_f32_16x16x32_bf16 v[152:155], v[20:23], v[52:55], v[152:155]
  ds_read_b128 v[116:119], v244 offset:3520
  v_mfma_f32_16x16x32_bf16 v[152:155], v[16:19], v[56:59], v[152:155]
  ds_read2_b32 v[84:85], v240 offset0:240 offset1:241
  v_mfma_f32_16x16x32_bf16 v[156:159], v[20:23], v[56:59], v[156:159]
  ds_read2_b32 v[86:87], v240 offset0:242 offset1:243
  v_mfma_f32_16x16x32_bf16 v[152:155], v[24:27], v[48:51], v[152:155]
  ds_read_b128 v[120:123], v244 offset:3008
  v_mfma_f32_16x16x32_bf16 v[156:159], v[24:27], v[52:55], v[156:159]
  ds_read2_b32 v[88:89], v241 offset0:112 offset1:113
  v_mfma_f32_16x16x32_bf16 v[160:163], v[24:27], v[56:59], v[160:163]
  ds_read2_b32 v[90:91], v241 offset0:114 offset1:115
  v_mfma_f32_16x16x32_bf16 v[156:159], v[16:19], v[60:63], v[156:159]
  ds_read_b128 v[124:127], v244 offset:2496
  v_mfma_f32_16x16x32_bf16 v[160:163], v[20:23], v[60:63], v[160:163]
  ds_read2_b32 v[92:93], v241 offset0:240 offset1:241
  v_mfma_f32_16x16x32_bf16 v[164:167], v[24:27], v[60:63], v[164:167]
  ds_read2_b32 v[94:95], v241 offset0:242 offset1:243
  v_mfma_f32_16x16x32_bf16 v[156:159], v[28:31], v[48:51], v[156:159]
  ds_read_b128 v[128:131], v244 offset:1984
  v_mfma_f32_16x16x32_bf16 v[160:163], v[28:31], v[52:55], v[160:163]
  ds_read2_b32 v[96:97], v242 offset0:112 offset1:113
  v_mfma_f32_16x16x32_bf16 v[164:167], v[28:31], v[56:59], v[164:167]
  ds_read2_b32 v[98:99], v242 offset0:114 offset1:115
  v_mfma_f32_16x16x32_bf16 v[168:171], v[28:31], v[60:63], v[168:171]
  ds_read_b128 v[132:135], v244 offset:1472
  v_mfma_f32_16x16x32_bf16 v[160:163], v[16:19], v[64:67], v[160:163]
  ds_read2_b32 v[100:101], v242 offset0:240 offset1:241
  v_mfma_f32_16x16x32_bf16 v[164:167], v[20:23], v[64:67], v[164:167]
  ds_read2_b32 v[102:103], v242 offset0:242 offset1:243
  v_mfma_f32_16x16x32_bf16 v[168:171], v[24:27], v[64:67], v[168:171]
  ds_read_b128 v[136:139], v244 offset:960
  v_mfma_f32_16x16x32_bf16 v[172:175], v[28:31], v[64:67], v[172:175]
  ds_read2_b32 v[104:105], v243 offset0:112 offset1:113
  v_mfma_f32_16x16x32_bf16 v[160:163], v[32:35], v[48:51], v[160:163]
  ds_read2_b32 v[106:107], v243 offset0:114 offset1:115
  v_mfma_f32_16x16x32_bf16 v[164:167], v[32:35], v[52:55], v[164:167]
  ds_read_b128 v[140:143], v244 offset:448
  v_mfma_f32_16x16x32_bf16 v[168:171], v[32:35], v[56:59], v[168:171]
  ds_read2_b32 v[108:109], v243 offset0:240 offset1:241
  v_mfma_f32_16x16x32_bf16 v[172:175], v[32:35], v[60:63], v[172:175]
  ds_read2_b32 v[110:111], v243 offset0:242 offset1:243
  v_mfma_f32_16x16x32_bf16 v[164:167], v[16:19], v[68:71], v[164:167]
  v_mfma_f32_16x16x32_bf16 v[168:171], v[20:23], v[68:71], v[168:171]
  v_mfma_f32_16x16x32_bf16 v[172:175], v[24:27], v[68:71], v[172:175]
  v_mfma_f32_16x16x32_bf16 v[164:167], v[36:39], v[48:51], v[164:167]
  v_mfma_f32_16x16x32_bf16 v[168:171], v[36:39], v[52:55], v[168:171]
  v_mfma_f32_16x16x32_bf16 v[172:175], v[36:39], v[56:59], v[172:175]
  v_mfma_f32_16x16x32_bf16 v[168:171], v[16:19], v[72:75], v[168:171]
  v_mfma_f32_16x16x32_bf16 v[172:175], v[20:23], v[72:75], v[172:175]
  v_mfma_f32_16x16x32_bf16 v[168:171], v[40:43], v[48:51], v[168:171]
  v_mfma_f32_16x16x32_bf16 v[172:175], v[40:43], v[52:55], v[172:175]
  v_mfma_f32_16x16x32_bf16 v[172:175], v[16:19], v[76:79], v[172:175]
  v_mfma_f32_16x16x32_bf16 v[172:175], v[44:47], v[48:51], v[172:175]
  s_waitcnt lgkmcnt(0)
  v_mfma_f32_16x16x32_bf16 v[172:175], v[80:83], v[140:143], v[172:175]
  v_mfma_f32_16x16x32_bf16 v[172:175], v[84:87], v[136:139], v[172:175]
  v_mfma_f32_16x16x32_bf16 v[172:175], v[88:91], v[132:135], v[172:175]
  v_mfma_f32_16x16x32_bf16 v[172:175], v[92:95], v[128:131], v[172:175]
  v_mfma_f32_16x16x32_bf16 v[172:175], v[96:99], v[124:127], v[172:175]
  v_mfma_f32_16x16x32_bf16 v[172:175], v[100:103], v[120:123], v[172:175]
  v_mfma_f32_16x16x32_bf16 v[172:175], v[104:107], v[116:119], v[172:175]
  v_mfma_f32_16x16x32_bf16 v[172:175], v[108:111], v[112:115], v[172:175]
  v_mfma_f32_16x16x32_bf16 v[168:171], v[80:83], v[136:139], v[168:171]
  v_mfma_f32_16x16x32_bf16 v[168:171], v[84:87], v[132:135], v[168:171]
  v_mfma_f32_16x16x32_bf16 v[168:171], v[88:91], v[128:131], v[168:171]
  v_mfma_f32_16x16x32_bf16 v[168:171], v[92:95], v[124:127], v[168:171]
  v_mfma_f32_16x16x32_bf16 v[168:171], v[96:99], v[120:123], v[168:171]
  v_mfma_f32_16x16x32_bf16 v[168:171], v[100:103], v[116:119], v[168:171]
  v_mfma_f32_16x16x32_bf16 v[168:171], v[104:107], v[112:115], v[168:171]
  s_nop 0
  v_cvt_pk_bf16_f32 v30, v172, v173
  v_cvt_pk_bf16_f32 v31, v174, v175
  buffer_store_dwordx2 v[30:31], v247, s[8:11], s21 offen offset:3584 sc1
  v_mfma_f32_16x16x32_bf16 v[164:167], v[80:83], v[132:135], v[164:167]
  v_mfma_f32_16x16x32_bf16 v[164:167], v[84:87], v[128:131], v[164:167]
  v_mfma_f32_16x16x32_bf16 v[164:167], v[88:91], v[124:127], v[164:167]
  s_nop 0
  v_cvt_pk_bf16_f32 v28, v168, v169
  v_cvt_pk_bf16_f32 v29, v170, v171
  buffer_store_dwordx2 v[28:29], v247, s[8:11], s21 offen offset:3072 sc1
  v_mfma_f32_16x16x32_bf16 v[164:167], v[92:95], v[120:123], v[164:167]
  v_mfma_f32_16x16x32_bf16 v[164:167], v[96:99], v[116:119], v[164:167]
  v_mfma_f32_16x16x32_bf16 v[164:167], v[100:103], v[112:115], v[164:167]
  v_mfma_f32_16x16x32_bf16 v[160:163], v[80:83], v[128:131], v[160:163]
  v_mfma_f32_16x16x32_bf16 v[160:163], v[84:87], v[124:127], v[160:163]
  v_mfma_f32_16x16x32_bf16 v[160:163], v[88:91], v[120:123], v[160:163]
  v_mfma_f32_16x16x32_bf16 v[160:163], v[92:95], v[116:119], v[160:163]
  v_mfma_f32_16x16x32_bf16 v[160:163], v[96:99], v[112:115], v[160:163]
  v_mfma_f32_16x16x32_bf16 v[156:159], v[80:83], v[124:127], v[156:159]
  v_mfma_f32_16x16x32_bf16 v[156:159], v[84:87], v[120:123], v[156:159]
  s_nop 0
  v_cvt_pk_bf16_f32 v26, v164, v165
  v_cvt_pk_bf16_f32 v27, v166, v167
  buffer_store_dwordx2 v[26:27], v247, s[8:11], s21 offen offset:2560 sc1
  v_mfma_f32_16x16x32_bf16 v[156:159], v[88:91], v[116:119], v[156:159]
  s_nop 0
  v_cvt_pk_bf16_f32 v24, v160, v161
  v_cvt_pk_bf16_f32 v25, v162, v163
  buffer_store_dwordx2 v[24:25], v247, s[8:11], s21 offen offset:2048 sc1
  v_mfma_f32_16x16x32_bf16 v[156:159], v[92:95], v[112:115], v[156:159]
  v_mfma_f32_16x16x32_bf16 v[152:155], v[80:83], v[120:123], v[152:155]
  v_mfma_f32_16x16x32_bf16 v[152:155], v[84:87], v[116:119], v[152:155]
  v_mfma_f32_16x16x32_bf16 v[152:155], v[88:91], v[112:115], v[152:155]
  v_mfma_f32_16x16x32_bf16 v[148:151], v[80:83], v[116:119], v[148:151]
  v_mfma_f32_16x16x32_bf16 v[148:151], v[84:87], v[112:115], v[148:151]
  v_mfma_f32_16x16x32_bf16 v[144:147], v[80:83], v[112:115], v[144:147]
  s_nop 1
  v_cvt_pk_bf16_f32 v22, v156, v157
  v_cvt_pk_bf16_f32 v23, v158, v159
  buffer_store_dwordx2 v[22:23], v247, s[8:11], s21 offen offset:1536 sc1
  v_cvt_pk_bf16_f32 v20, v152, v153
  v_cvt_pk_bf16_f32 v21, v154, v155
  buffer_store_dwordx2 v[20:21], v247, s[8:11], s21 offen offset:1024 sc1
  v_cvt_pk_bf16_f32 v18, v148, v149
  v_cvt_pk_bf16_f32 v19, v150, v151
  buffer_store_dwordx2 v[18:19], v247, s[8:11], s21 offen offset:512 sc1
  v_cvt_pk_bf16_f32 v16, v144, v145
  v_cvt_pk_bf16_f32 v17, v146, v147
  buffer_store_dwordx2 v[16:17], v247, s[8:11], s21 offen offset:0 sc1
  v_mov_b32 v40, 1
  v_lshlrev_b32 v41, 7, v0
  v_cmp_gt_u32 vcc, 8, v0
  s_waitcnt vmcnt(0)
  s_barrier
  s_and_saveexec_b64 s[22:23], vcc
  s_cbranch_execz C_done
  buffer_atomic_add v40, v41, s[8:11], s65 offen sc1
C_done:
  s_mov_b64 exec, s[22:23]
  s_endpgm
k2_end:
.section .rodata,"a"
.p2align 6
.amdhsa_kernel k1_kernel
  .amdhsa_next_free_vgpr 256
  .amdhsa_next_free_sgpr 96
  .amdhsa_accum_offset 256
  .amdhsa_group_segment_fixed_size 0
  .amdhsa_kernarg_size 136
  .amdhsa_user_sgpr_count 2
  .amdhsa_user_sgpr_kernarg_segment_ptr 1
  .amdhsa_system_sgpr_workgroup_id_x 1
  .amdhsa_float_denorm_mode_32 3
.end_amdhsa_kernel
.p2align 6
.amdhsa_kernel k2_kernel
  .amdhsa_next_free_vgpr 256
  .amdhsa_next_free_sgpr 96
  .amdhsa_accum_offset 256
  .amdhsa_group_segment_fixed_size 0
  .amdhsa_kernarg_size 136
  .amdhsa_user_sgpr_count 2
  .amdhsa_user_sgpr_kernarg_segment_ptr 1
  .amdhsa_system_sgpr_workgroup_id_x 1
  .amdhsa_float_denorm_mode_32 3
.end_amdhsa_kernel
```
